```python
import torch

def _softmax(x, axis=-1):
    return torch.softmax(x, dim=axis)
def _gelu(x):
    return torch.nn.functional.gelu(x, approximate="tanh")
def _silu(x):
    return torch.nn.functional.silu(x)
def _sigmoid(x):
    return torch.sigmoid(x)
def _layernorm(x, axis=-1, eps=1e-5):
    m = x.mean(dim=axis, keepdim=True)
    v = x.var(dim=axis, keepdim=True, unbiased=False)
    return (x - m) / torch.sqrt(v + eps)
def _scatter_add(tgt, idx, src, axis=0):
    return tgt.clone().index_add_(axis, idx, src)
def _segment_sum(src, seg, n):
    out = torch.zeros((n,) + src.shape[1:], dtype=src.dtype)
    return out.index_add_(0, seg, src)
def _pad(x, pw):
    flat = tuple(v for pair in reversed(pw) for v in pair)
    return torch.nn.functional.pad(x, flat)

kernel_name = 'recurrent_scan__sliding_block_cached__dense_activation_squared_relu__decode'

def setup_inputs():

    _w = (lambda a: (lambda t: t.to(torch.bfloat16) if t.is_floating_point() else t)(torch.as_tensor(a)))
    def _A_setup():
        B, Sq, D = 2, 1, 448
        Hq, Hkv, Sk, Dh = 16, 8, 8192, 256
        assert Hq % Hkv == 0, (Hq, Hkv)
        return {
            "x": _w((lambda *s: torch.randn(*s, dtype=torch.bfloat16) * 0.05)(B, Sq, D)),
            "k_cache": _w((lambda *s: torch.randn(*s, dtype=torch.bfloat16) * 0.8)(B, Hkv, Sk, Dh)),
            "v_cache": _w((lambda *s: torch.randn(*s, dtype=torch.bfloat16) * 0.2)(B, Hkv, Sk, Dh)),
            "wq": _w((lambda *s: torch.randn(*s, dtype=torch.bfloat16) * 0.8)(D, Hq * Dh) * (D ** -0.5)),
            "wo": _w((lambda *s: torch.randn(*s, dtype=torch.bfloat16) * 0.2)(Hq * Dh, D) * ((Hq * Dh) ** -0.5)),
        }
    _A_in = _A_setup()

    def _B_setup():
        B, S, D, F = 2, 1, 448, 1792
        return {
            "x": _w((lambda *s: torch.randn(*s, dtype=torch.bfloat16) * 0.05)(B, S, D)),
            "w1": _w((lambda *s: torch.randn(*s, dtype=torch.bfloat16) * 0.1)(D, F)),
            "b1": _w((lambda *s: torch.randn(*s, dtype=torch.bfloat16) * 0.4)(F)),
            "w2": _w((lambda *s: torch.randn(*s, dtype=torch.bfloat16) * 0.1)(F, D)),
            "b2": _w((lambda *s: torch.randn(*s, dtype=torch.bfloat16) * 6.4)(D)),
        }
    _B_in = _B_setup()

    return {
        "A_x": _A_in["x"],
        "A_k_cache": _A_in["k_cache"],
        "A_v_cache": _A_in["v_cache"],
        "A_wq": _A_in["wq"],
        "A_wo": _A_in["wo"],
        "B_x": _B_in["x"],
        "B_w1": _B_in["w1"],
        "B_b1": _B_in["b1"],
        "B_w2": _B_in["w2"],
        "B_b2": _B_in["b2"],
    }

def reference(A_x, A_k_cache, A_v_cache, A_wq, A_wo, B_x, B_w1, B_b1, B_w2, B_b2):
    def _A_ref(x, k_cache, v_cache, wq, wo):
        B, Sq, D = x.shape
        Hq, Dh = 16, 256
        Hkv, Sk = k_cache.shape[1], k_cache.shape[2]
        W = min(4096, max(256, Sk // 4))
        rep = Hq // Hkv
        q = (lambda x, *d: x.permute(*d))((x @ wq).reshape(B, Sq, Hq, Dh), 0, 2, 1, 3)
        k = (lambda x, n, axis: torch.repeat_interleave(x, n, dim=axis))(k_cache[:, :, Sk - W:, :], rep, axis=1)
        v = (lambda x, n, axis: torch.repeat_interleave(x, n, dim=axis))(v_cache[:, :, Sk - W:, :], rep, axis=1)
        scores = torch.einsum("bhqd,bhkd->bhqk", q, k) * (Dh ** -0.5)
        p = _softmax(scores, axis=-1)
        o = torch.einsum("bhqk,bhkd->bhqd", p, v)
        return (lambda x, *d: x.permute(*d))(o, 0, 2, 1, 3).reshape(B, Sq, Hq * Dh) @ wo

    def _B_ref(x, w1, b1, w2, b2):
        h = torch.einsum("bsd,df->bsf", x, w1) + b1
        zero = torch.zeros_like(h)
        r = torch.where(h > zero, h, zero)
        h = r * r
        out = torch.einsum("bsf,fd->bsd", h, w2) + b2
        return out

    x = A_x
    xn = _layernorm(x, axis=-1)
    s = _A_ref(xn, A_k_cache, A_v_cache, A_wq, A_wo)
    g = _silu(_B_ref(xn, B_w1, B_b1, B_w2, B_b2))
    return x + s * g
```

```asm
; @launch grid=(256,1,1) block=(320,1,1) lds=158720
.amdgcn_target "amdgcn-amd-amdhsa--gfx950"
.text
.globl recurrent_scan__sliding_block_cached__dense_activation_squared_relu__decode_kernel
.p2align 8
.type recurrent_scan__sliding_block_cached__dense_activation_squared_relu__decode_kernel,@function
recurrent_scan__sliding_block_cached__dense_activation_squared_relu__decode_kernel:
    s_lshr_b32 s5, s2, 3
    s_cmp_ge_u32 s5, 32
    s_cbranch_scc1 L_end
    s_load_dwordx2 s[44:45], s[0:1], 24
    s_load_dwordx16 s[16:31], s[0:1], 0

    v_lshrrev_b32 v2, 6, v0
    s_load_dwordx8 s[32:39], s[0:1], 64
    s_load_dwordx2 s[40:41], s[0:1], 96
    v_readfirstlane_b32 s3, v2
    s_and_b32 s4, s2, 7
    s_mov_b32 s47, 0x20000
    s_cmp_lg_u32 s3, 0
    s_cbranch_scc1 L_awave
    s_getpc_b64 s[12:13]
L_pc:
    s_mul_i32 s14, s5, ((L_codeend-L_pc-512)/124)*4
    v_lshl_add_u32 v27, v0, 3, s14
    global_load_dword v18, v27, s[12:13]
    v_lshrrev_b32 v8, 3, v0
    v_and_b32 v9, 6, v8
    v_and_b32 v10, 7, v0
    v_xor_b32 v10, v10, v9
    v_lshlrev_b32 v8, 13, v8
    v_lshl_add_u32 v5, v10, 4, v8
    v_add_u32 v7, 64512, v5
    v_lshlrev_b32 v6, 4, v0
    s_and_b32 s9, s5, 7
    s_lshr_b32 s10, s5, 3
    s_mulk_i32 s10, 7168
    s_lshl3_add_u32 s11, s4, s9
    s_add_u32 s10, s10, s11
    s_lshl_b32 s10, s10, 7
    s_mov_b32 s46, 3670016
    s_mov_b32 m0, 0
    s_mov_b32 s14, 6
    s_waitcnt lgkmcnt(0)
    global_load_dwordx4 v[8:11], v6, s[16:17]
    global_load_dwordx4 v[12:15], v6, s[16:17] offset:768
L_wq:
    buffer_load_dwordx4 v5, s[44:47], s10 offen nt lds
    buffer_load_dwordx4 v7, s[44:47], s10 offen offset:1024 nt lds
    s_addk_i32 m0, 2048
    s_add_u32 s10, s10, s47
    s_sub_u32 s14, s14, 1
    s_cbranch_scc0 L_wq
    s_branch L_auxc

L_awave:
    v_and_b32 v1, 63, v0
    s_sub_u32 s8, s3, 1
    s_lshr_b32 s6, s5, 4
    s_and_b32 s7, s5, 15
    v_lshrrev_b32 v8, 5, v1
    v_and_b32 v10, 31, v1
    v_xor_b32 v11, v10, v8
    v_lshlrev_b32 v9, 9, v8
    v_lshl_add_u32 v5, v11, 4, v9
    s_lshl3_add_u32 s10, s6, s4

    s_lshl_b32 s10, s10, 22
    s_lshl_b32 s11, s7, 16
    s_add_u32 s10, s10, s11
    s_add_u32 s10, s10, 3145728
    s_mul_i32 s15, s7, 5
    s_lshl4_add_u32 s11, s8, s15
    s_lshl_b32 s11, s11, 10
    s_and_b32 s11, s11, 0xffff
    s_mul_i32 s12, s8, 16896
    s_add_u32 m0, s12, 25600
    s_mov_b32 s50, 0x4000000
    s_mov_b32 s51, 0x20000
    s_mov_b32 s14, 15

    s_waitcnt lgkmcnt(0)
    s_mov_b32 s48, s18
    s_mov_b32 s49, s19

    s_barrier
L_kloop:
    s_add_u32 s13, s10, s11
    s_add_u32 s11, s11, 1024
    buffer_load_dwordx4 v5, s[48:51], s13 offen nt lds
    s_and_b32 s11, s11, 0xffff
    s_addk_i32 m0, 1056
    s_sub_u32 s14, s14, 1

    s_waitcnt vmcnt(5)
    s_cbranch_scc0 L_kloop
    s_branch L_av

L_auxc:
    v_mov_b32 v29, 0
    v_lshrrev_b32 v2, 4, v0
    global_load_dword v4, v29, s[40:41] sc1
    v_lshrrev_b32 v20, 2, v0
    v_mul_u32_u24 v20, 3584, v20
    v_lshlrev_b32 v21, 1, v2
    v_xor_b32 v21, v21, v0
    v_and_b32 v21, 3, v21
    v_lshl_add_u32 v5, v21, 4, v20
    v_add_u32 v7, 56320, v5
    s_lshr_b32 s8, s5, 3

    s_lshl_b32 s12, s4, 2
    s_lshr_b32 s90, 0x68288888, s12
    s_lshr_b32 s12, 0x66000000, s12
    s_and_b32 s90, s90, 15
    s_and_b32 s12, s12, 15
    s_lshl_b32 s91, s4, 3
    s_sub_u32 s91, s91, s12

    s_add_u32 s15, s91, s9
    s_mul_i32 s11, s8, 401408
    s_lshl_b32 s12, s15, 6
    s_add_u32 s11, s11, s12
    s_mov_b32 s48, s28
    s_mov_b32 s49, s29
    s_cmp_lt_u32 s9, s90
    s_cselect_b32 s50, 1605632, 0
    s_mov_b32 s51, 0x20000

    buffer_load_dwordx4 v5, s[48:51], s11 offen nt lds
    buffer_load_dwordx4 v7, s[48:51], s11 offen offset:1024 nt lds
    s_addk_i32 m0, 2048
    s_add_u32 s11, s11, 114688

    buffer_load_dwordx4 v5, s[48:51], s11 offen nt lds
    buffer_load_dwordx4 v7, s[48:51], s11 offen offset:1024 nt lds
    s_addk_i32 m0, 2048
    s_add_u32 s11, s11, 114688

    buffer_load_dwordx4 v5, s[48:51], s11 offen nt lds
    buffer_load_dwordx4 v7, s[48:51], s11 offen offset:1024 nt lds
    s_addk_i32 m0, 2048
    s_add_u32 s11, s11, 114688

    buffer_load_dwordx4 v5, s[48:51], s11 offen nt lds
    v_and_b32 v3, 15, v0
    v_mov_b32 v1, v0
    s_lshr_b32 s6, s5, 4
    s_and_b32 s7, s5, 15
    v_and_b32 v24, 1, v3
    v_and_b32 v25, 14, v3
    v_lshl_add_u32 v25, v2, 4, v25
    v_lshlrev_b32 v25, 3, v25
    v_lshl_add_u32 v16, v24, 14, v25
    v_lshl_add_u32 v17, v24, 8, v25
    s_lshl3_add_u32 s84, s4, s8
    s_lshl3_add_u32 s84, s84, s9
    s_lshl_b32 s84, s84, 9
    s_add_u32 s84, s84, 4096
    s_lshl2_add_u32 s85, s15, s8
    s_lshl_b32 s85, s85, 9
    s_add_u32 s85, s85, 266240

    s_mov_b32 s52, s40
    s_mov_b32 s53, s41
    s_mov_b32 s54, 268435456
    s_mov_b32 s55, 0x20000

    buffer_load_dwordx4 v[112:115], v16, s[52:55], s84 offen nt
    s_mov_b32 exec_hi, 0
    buffer_load_dwordx4 v[116:119], v17, s[52:55], s85 offen nt

    s_mov_b32 exec_hi, -1
    s_barrier
    s_sub_u32 s13, s90, 1
    s_min_u32 s13, s9, s13
    s_add_u32 s14, s91, s13
    s_lshl_b32 s13, s14, 6
    v_lshl_add_u32 v26, v3, 2, s13
    global_load_dword v28, v26, s[30:31]
    s_mov_b32 s42, 100000
    s_branch L_aux2

L_av:
    s_lshl_b32 s9, s8, 1
    v_add_u32 v8, s9, v8
    v_lshlrev_b32 v8, 1, v8
    v_xor_b32 v11, v10, v8
    v_lshl_add_u32 v7, v11, 4, v9
    s_add_u32 s11, s15, s8
    s_lshl_b32 s11, s11, 10
    s_and_b32 s11, s11, 0xffff
    s_lshl_b32 s12, s8, 10
    s_add_u32 s12, s12, 93184
    s_mov_b32 s48, s20
    s_mov_b32 s49, s21

    s_add_u32 s13, s10, s11
    s_mov_b32 m0, s12
    s_add_u32 s11, s11, 4096
    buffer_load_dwordx4 v7, s[48:51], s13 offen nt lds
    s_and_b32 s11, s11, 0xffff
    s_add_u32 s12, s12, 4096

    s_mov_b32 s52, s40
    s_mov_b32 s53, s41
    s_mov_b32 s54, 268435456
    s_mov_b32 s55, 0x20000
    v_lshrrev_b32 v2, 4, v1
    v_and_b32 v3, 15, v1
    s_mov_b32 s42, 100000

    v_lshrrev_b32 v8, 1, v3
    v_mul_u32_u24 v8, 1056, v8
    v_and_b32 v9, 1, v3
    v_lshl_add_u32 v8, v9, 9, v8
    v_xor_b32 v9, v2, v9
    v_lshl_add_u32 v8, v9, 4, v8
    s_mul_i32 s13, s8, 16896
    s_add_u32 s13, s13, 25600
    v_add_u32 v8, s13, v8
    v_and_b32 v13, 1, v3
    v_lshlrev_b32 v12, 9, v13
    v_lshl_add_u32 v12, v2, 4, v12
    v_add_u32 v12, 23296, v12
    v_lshrrev_b32 v14, 2, v3
    v_lshl_add_u32 v14, v2, 2, v14
    v_and_b32 v15, 7, v14
    v_lshlrev_b32 v15, 5, v15
    v_and_b32 v25, 3, v3
    v_lshlrev_b32 v25, 3, v25
    s_lshl_b32 s13, s8, 7
    v_add_u32 v16, s13, v25
    v_xor_b32 v16, v16, v15
    v_lshl_add_u32 v16, v14, 9, v16
    v_add_u32 v16, 93184, v16
    v_xor_b32 v17, 32, v16
    v_xor_b32 v18, 64, v16
    v_xor_b32 v19, 96, v16
    v_lshlrev_b32 v27, 4, v13
    v_lshl_add_u32 v22, v2, 5, v27
    v_add_u32 v20, 24832, v27
    s_lshl_b32 s13, s8, 2
    v_add_u32 v21, s13, v20
    v_add_u32 v22, 24320, v22
    s_lshl_b32 s13, s8, 7
    v_add_u32 v23, s13, v22
    s_lshl_b32 s91, s4, 1
    s_add_u32 s91, s91, s6
    s_lshl_b32 s91, s91, 7
    s_and_b32 s13, s7, 6
    s_lshl_b32 s13, s13, 3
    s_add_u32 s91, s91, s13
    s_and_b32 s13, s7, 1
    s_lshl3_add_u32 s91, s13, s91
    s_lshr_b32 s13, s7, 3
    s_lshl2_add_u32 s91, s13, s91
    s_add_u32 s91, s91, s8
    s_lshl_b32 s91, s91, 4
    s_add_u32 s91, s91, 786432
    v_lshlrev_b32 v169, 10, v13
    s_lshl_b32 s92, s4, 2
    s_add_u32 s92, s92, s8
    s_lshl_b32 s92, s92, 14
    s_lshl_b32 s13, s6, 11
    s_add_u32 s92, s92, s13
    s_lshl_b32 s13, s7, 7
    s_add_u32 s92, s92, s13
    s_add_u32 s92, s92, 819200
    v_lshlrev_b32 v15, 12, v2
    v_lshl_add_u32 v15, v3, 4, v15

    s_mov_b32 s56, 0xffff0000
    s_mov_b32 s57, 0
    s_mov_b32 s58, 0
    s_mov_b32 s59, 0x0000ffff
    s_mov_b32 s60, 0
    s_mov_b32 s61, 0xffff0000
    s_mov_b32 s62, 0xaaaaaaaa
    s_mov_b32 s63, 0xaaaaaaaa

    s_waitcnt vmcnt(5)
    s_add_u32 s13, s10, s11
    s_mov_b32 m0, s12
    s_add_u32 s11, s11, 4096
    buffer_load_dwordx4 v7, s[48:51], s13 offen nt lds
    s_and_b32 s11, s11, 0xffff
    s_add_u32 s12, s12, 4096

    v_lshlrev_b32 v160, 4, v1
    v_mul_u32_u24 v161, 2341, v1
    v_lshrrev_b32 v161, 16, v161
    v_mul_u32_u24 v161, 228928, v161
    v_add_u32 v161, v161, v160
    s_mov_b32 s96, s24
    s_mov_b32 s97, s25
    s_mov_b32 s98, 3670016
    s_mov_b32 s99, 0x20000
    s_lshr_b32 s15, s8, 1
    s_and_b32 s43, s8, 1
    s_lshl_b32 s84, s4, 7
    s_lshl_b32 s13, s7, 2
    s_add_u32 s84, s84, s13
    s_add_u32 s84, s84, s8
    s_mul_i32 s84, s84, 3584
    s_mul_i32 s13, s6, 448
    s_add_u32 s84, s84, s13
    s_mul_i32 s87, s8, 3712
    s_add_u32 s87, s87, 25600

    v_mul_u32_u24 v162, 928, v14
    v_add_u32 v162, v162, v25

    s_mul_i32 s13, s43, 224
    s_add_u32 s13, s13, 25600
    v_add_u32 v162, s13, v162
    s_lshl_b32 s86, s4, 1
    s_add_u32 s86, s86, s15
    s_lshl_b32 s86, s86, 11
    s_add_u32 s86, s86, 786432
    s_lshl_b32 s89, s4, 4
    s_add_u32 s89, s89, s7
    s_lshl_b32 s85, s89, 1
    s_add_u32 s85, s85, s15
    s_lshl_b32 s85, s85, 11
    s_add_u32 s85, s85, 819200
    s_lshl_b32 s88, s15, 2
    s_lshl_b32 s13, s6, 1
    s_add_u32 s88, s88, s13
    s_add_u32 s88, s88, s43
    s_lshl_b32 s88, s88, 16

    s_lshl_b32 s13, s89, 7
    s_add_u32 s88, s88, s13
    s_add_u32 s88, s88, 1867776
    v_and_b32 v24, 3, v3

    v_lshrrev_b32 v146, 1, v14
    v_and_b32 v147, 7, v1
    v_lshlrev_b32 v147, 4, v147
    v_lshrrev_b32 v145, 2, v1
    v_lshlrev_b32 v145, 7, v145
    v_lshl_add_u32 v145, v24, 4, v145
    s_lshr_b32 s13, s89, 1
    s_and_b32 s14, s89, 1
    s_lshl_b32 s14, s14, 6

    v_and_b32 v147, 1, v1
    v_lshlrev_b32 v147, 4, v147
    v_lshrrev_b32 v145, 1, v1
    v_lshl_add_u32 v145, v145, 7, v147
    v_and_b32 v146, 12, v1
    v_lshl_add_u32 v163, v146, 3, v147
    v_lshl_add_u32 v163, v2, 14, v163
    s_lshr_b32 s13, s89, 2
    s_lshl_b32 s90, s13, 14
    s_and_b32 s14, s89, 3
    s_lshl_b32 s14, s14, 5
    s_add_u32 s90, s90, s14
    s_add_u32 s90, s90, 1867776
    s_add_u32 s93, s90, 4096

    s_mul_i32 s9, s89, 1792
    s_add_u32 s9, s9, 2916352
    s_and_b32 s13, s4, 3
    s_mul_i32 s13, s13, 112
    s_lshl_b32 s14, s7, 2
    s_add_u32 s13, s13, s14
    s_cmp_lt_u32 s7, 12
    s_cselect_b32 s14, 16, 0
    v_and_b32 v166, 4, v1
    v_mul_u32_u24 v166, s14, v166
    v_add3_u32 v166, v166, v24, s13
    v_lshlrev_b32 v166, 1, v166
    s_lshr_b32 s13, s4, 2
    s_mul_i32 s13, s13, 896
    v_add_u32 v165, s13, v166
    v_mul_u32_u24 v164, 1792, v14
    v_and_b32 v146, 1, v1
    v_lshl_add_u32 v164, v146, 4, v164
    s_lshl_b32 s13, s43, 9
    s_add_u32 s13, s13, 21504
    v_lshl_add_u32 v175, v1, 3, s13

    s_lshl_b32 s13, s4, 2
    s_lshr_b32 s33, 0x68288888, s13
    s_lshr_b32 s13, 0x66000000, s13
    s_and_b32 s33, s33, 15
    s_and_b32 s13, s13, 15
    s_lshl_b32 s32, s4, 3
    s_sub_u32 s32, s32, s13

    s_and_b32 s13, s5, 7
    s_cmp_lt_u32 s13, s33
    s_cselect_b32 s33, s15, 0
    s_add_u32 s32, s32, s13
    s_lshl_b32 s32, s32, 5
    s_lshr_b32 s13, s5, 3
    s_lshl_b32 s14, s43, 2
    s_add_u32 s13, s13, s14
    s_mul_i32 s13, s13, 28672
    s_add_u32 s32, s32, s13
    s_add_u32 s32, s32, 2916352

    v_mov_b32 v144, 1.0
    s_cmp_lg_u32 s33, 0
    s_cselect_b32 s44, 0x33333333, 0
    s_mov_b32 s45, s44
    s_cmp_eq_u32 s3, 1
    s_cselect_b32 s13, s6, 0
    s_cmp_lg_u32 s13, 0
    s_cselect_b64 s[46:47], -1, 0

    s_waitcnt vmcnt(5)
    s_mov_b32 s14, 4
L_vloop1:
    s_add_u32 s13, s10, s11
    s_mov_b32 m0, s12
    s_add_u32 s11, s11, 4096
    buffer_load_dwordx4 v7, s[48:51], s13 offen nt lds
    s_and_b32 s11, s11, 0xffff
    s_add_u32 s12, s12, 4096

    s_waitcnt vmcnt(5)
    s_sub_u32 s14, s14, 1
    s_cmp_lg_u32 s14, 0
    s_cbranch_scc1 L_vloop1

    ds_read_b128 v[64:67], v8 offset:0
    ds_read_b128 v[96:99], v8 offset:8448
    ds_read_b128 v[68:71], v8 offset:64
    ds_read_b128 v[100:103], v8 offset:8512
    ds_read_b128 v[72:75], v8 offset:128
    ds_read_b128 v[104:107], v8 offset:8576
    ds_read_b128 v[76:79], v8 offset:192
    ds_read_b128 v[108:111], v8 offset:8640
    ds_read_b128 v[80:83], v8 offset:256
    ds_read_b128 v[112:115], v8 offset:8704
    ds_read_b128 v[84:87], v8 offset:320
    ds_read_b128 v[116:119], v8 offset:8768
    ds_read_b128 v[88:91], v8 offset:384
    ds_read_b128 v[120:123], v8 offset:8832
    ds_read_b128 v[92:95], v8 offset:448
    ds_read_b128 v[124:127], v8 offset:8896
    global_load_ushort v167, v165, s[16:17]
    global_load_ushort v168, v166, s[34:35]

    s_mov_b64 exec, 1
    buffer_load_dword v174, v169, s[52:55], s91 offen nt
    s_mov_b64 exec, -1
    s_mov_b32 s14, 4
L_vloop2:
    s_add_u32 s13, s10, s11
    s_mov_b32 m0, s12
    s_add_u32 s11, s11, 4096
    buffer_load_dwordx4 v7, s[48:51], s13 offen nt lds
    s_and_b32 s11, s11, 0xffff
    s_add_u32 s12, s12, 4096

    s_sub_u32 s14, s14, 1
    s_cmp_lg_u32 s14, 0
    s_cbranch_scc1 L_vloop2

    s_barrier
    ds_read_b64 v[4:5], v20 offset:64
    ds_read_b128 v[32:35], v12 offset:0
    ds_read_b128 v[36:39], v12 offset:64
    ds_read_b128 v[40:43], v12 offset:128
    ds_read_b128 v[44:47], v12 offset:192
    ds_read_b128 v[48:51], v12 offset:256
    ds_read_b128 v[52:55], v12 offset:320
    ds_read_b128 v[56:59], v12 offset:384
    ds_read_b128 v[60:63], v12 offset:448
    s_add_u32 s14, s10, s11
    s_mov_b32 m0, s12
    s_add_u32 s11, s11, 4096
    buffer_load_dwordx4 v7, s[48:51], s14 offen nt lds
    s_and_b32 s11, s11, 0xffff
    s_add_u32 s12, s12, 4096

    s_waitcnt lgkmcnt(7)
    v_mfma_f32_16x16x32_bf16 v[128:131], v[64:67], v[32:35], 0
    v_mfma_f32_16x16x32_bf16 v[132:135], v[96:99], v[32:35], 0
    s_waitcnt lgkmcnt(6)
    v_mfma_f32_16x16x32_bf16 v[128:131], v[68:71], v[36:39], v[128:131]
    v_mfma_f32_16x16x32_bf16 v[132:135], v[100:103], v[36:39], v[132:135]
    s_waitcnt lgkmcnt(5)
    v_mfma_f32_16x16x32_bf16 v[128:131], v[72:75], v[40:43], v[128:131]
    v_mfma_f32_16x16x32_bf16 v[132:135], v[104:107], v[40:43], v[132:135]
    s_waitcnt lgkmcnt(4)
    v_mfma_f32_16x16x32_bf16 v[128:131], v[76:79], v[44:47], v[128:131]
    v_mfma_f32_16x16x32_bf16 v[132:135], v[108:111], v[44:47], v[132:135]
    s_waitcnt lgkmcnt(3)
    v_mfma_f32_16x16x32_bf16 v[128:131], v[80:83], v[48:51], v[128:131]
    v_mfma_f32_16x16x32_bf16 v[132:135], v[112:115], v[48:51], v[132:135]
    s_waitcnt lgkmcnt(2)
    v_mfma_f32_16x16x32_bf16 v[128:131], v[84:87], v[52:55], v[128:131]
    v_mfma_f32_16x16x32_bf16 v[132:135], v[116:119], v[52:55], v[132:135]
    s_waitcnt lgkmcnt(1)
    v_mfma_f32_16x16x32_bf16 v[128:131], v[88:91], v[56:59], v[128:131]
    v_mfma_f32_16x16x32_bf16 v[132:135], v[120:123], v[56:59], v[132:135]
    s_waitcnt lgkmcnt(0)
    v_mfma_f32_16x16x32_bf16 v[128:131], v[92:95], v[60:63], v[128:131]
    v_mfma_f32_16x16x32_bf16 v[132:135], v[124:127], v[60:63], v[132:135]
    s_add_u32 s14, s10, s11
    s_mov_b32 m0, s12
    s_add_u32 s11, s11, 4096
    buffer_load_dwordx4 v7, s[48:51], s14 offen nt lds
    s_and_b32 s11, s11, 0xffff
    s_add_u32 s12, s12, 4096

    v_readfirstlane_b32 s43, v5
    v_cvt_pk_bf16_f32 v32, v128, v129
    v_cvt_pk_bf16_f32 v33, v130, v131
    v_cvt_pk_bf16_f32 v34, v132, v133
    v_cvt_pk_bf16_f32 v35, v134, v135
    v_lshlrev_b32 v128, 16, v32
    v_and_b32 v129, 0xffff0000, v32
    v_lshlrev_b32 v130, 16, v33
    v_and_b32 v131, 0xffff0000, v33
    v_lshlrev_b32 v132, 16, v34
    v_and_b32 v133, 0xffff0000, v34
    v_lshlrev_b32 v134, 16, v35
    v_and_b32 v135, 0xffff0000, v35
    v_max3_f32 v36, v128, v129, v130
    v_max3_f32 v37, v131, v132, v133
    v_max3_f32 v36, v36, v134, v135
    v_max_f32 v36, v36, v37

    v_mov_b32 v37, v36
    s_nop 1
    v_permlane16_swap_b32 v36, v37
    v_max_f32 v36, v36, v37
    v_mov_b32 v37, v36
    s_nop 1
    v_permlane32_swap_b32 v36, v37
    v_max_f32 v36, v36, v37
    s_mov_b64 exec, 3
    ds_write_b32 v21, v36
    s_mov_b64 exec, -1

    s_add_u32 s14, s10, s11
    s_mov_b32 m0, s12
    s_add_u32 s11, s11, 4096
    buffer_load_dwordx4 v7, s[48:51], s14 offen nt lds
    s_and_b32 s11, s11, 0xffff
    s_add_u32 s12, s12, 4096

    s_add_u32 s14, s10, s11
    s_mov_b32 m0, s12
    s_add_u32 s11, s11, 4096
    buffer_load_dwordx4 v7, s[48:51], s14 offen nt lds
    s_and_b32 s11, s11, 0xffff
    s_add_u32 s12, s12, 4096

    s_waitcnt lgkmcnt(0)
    s_barrier
    ds_read_b128 v[36:39], v20

    s_add_u32 s14, s10, s11
    s_mov_b32 m0, s12
    s_add_u32 s11, s11, 4096
    buffer_load_dwordx4 v7, s[48:51], s14 offen nt lds
    s_and_b32 s11, s11, 0xffff
    s_add_u32 s12, s12, 4096

    s_add_u32 s14, s10, s11
    s_mov_b32 m0, s12
    s_add_u32 s11, s11, 4096
    buffer_load_dwordx4 v7, s[48:51], s14 offen nt lds
    s_and_b32 s11, s11, 0xffff
    s_add_u32 s12, s12, 4096

    s_mov_b32 s13, 0x3db8aa3b
    s_waitcnt lgkmcnt(0)
    v_max3_f32 v36, v36, v37, v38
    v_max_f32 v36, v36, v39
    v_mul_f32 v26, s13, v36
    v_and_b32 v26, 0xffffff00, v26

    v_fma_f32 v128, v128, s13, -v26
    v_fma_f32 v129, v129, s13, -v26
    v_fma_f32 v130, v130, s13, -v26
    v_fma_f32 v131, v131, s13, -v26
    v_fma_f32 v132, v132, s13, -v26
    v_fma_f32 v133, v133, s13, -v26
    v_fma_f32 v134, v134, s13, -v26
    v_fma_f32 v135, v135, s13, -v26
    v_exp_f32 v128, v128
    v_exp_f32 v129, v129
    v_exp_f32 v130, v130
    v_exp_f32 v131, v131
    v_exp_f32 v132, v132
    v_exp_f32 v133, v133
    v_exp_f32 v134, v134
    v_exp_f32 v135, v135
    v_cvt_pk_bf16_f32 v32, v128, v129
    v_cvt_pk_bf16_f32 v33, v130, v131
    v_cvt_pk_bf16_f32 v34, v132, v133
    v_cvt_pk_bf16_f32 v35, v134, v135
    v_add_f32 v36, v128, v129
    v_add_f32 v37, v130, v131
    v_add_f32 v38, v132, v133
    v_add_f32 v39, v134, v135
    v_add_f32 v36, v36, v37
    v_add_f32 v38, v38, v39
    v_add_f32 v36, v36, v38
    s_mov_b32 exec_lo, 0x00030003
    s_mov_b32 exec_hi, 0x00030003
    ds_write_b128 v23, v[32:35]
    s_mov_b64 exec, -1

    s_nop 1
    v_mov_b32_dpp v54, v26 quad_perm:[1,1,1,1] row_mask:0xf bank_mask:0xf
    v_mov_b32 v148, 0xff
    v_lshrrev_b32 v149, 8, v4
    v_bfe_u32 v150, v4, 16, 8
    v_lshrrev_b32 v151, 24, v4
    v_mov_b32 v152, 0x0c0c0400
    v_and_b32 v179, 0xff, v4
    s_cmp_eq_u32 s43, 0

    v_or_b32 v52, v26, v179
    v_or_b32 v54, v54, v150
    v_mov_b32 v37, v36
    s_nop 1
    v_permlane16_swap_b32 v36, v37
    v_add_f32 v36, v36, v37
    v_mov_b32 v37, v36
    s_nop 1
    v_permlane32_swap_b32 v36, v37
    v_add_f32 v36, v36, v37
    s_nop 1
    v_mov_b32_dpp v55, v36 quad_perm:[1,1,1,1] row_mask:0xf bank_mask:0xf
    v_bfi_b32 v53, v148, v149, v36
    v_bfi_b32 v55, v148, v151, v55

    s_mov_b64 exec, 1
    s_cbranch_scc1 L_st_far
    buffer_store_dwordx4 v[52:55], v169, s[52:55], s91 offen
L_st_done:
    s_mov_b64 exec, -1

    s_mov_b32 exec_hi, 0x00ffffff
    s_mov_b32 m0, s87
    s_add_u32 s87, s87, 928
    buffer_load_dwordx4 v161, s[96:99], s84 offen nt lds
    s_add_u32 s84, s84, 896

    s_mov_b32 exec_hi, -1
    s_waitcnt vmcnt(5) lgkmcnt(0)
    s_barrier
    ds_read_b128 v[32:35], v22 offset:0
    ds_read_b128 v[36:39], v22 offset:128
    ds_read_b128 v[40:43], v22 offset:256
    ds_read_b128 v[44:47], v22 offset:384
    ds_read_b64_tr_b16 v[64:65], v16 offset:0
    ds_read_b64_tr_b16 v[66:67], v16 offset:8192
    ds_read_b64_tr_b16 v[68:69], v17 offset:0
    ds_read_b64_tr_b16 v[70:71], v17 offset:8192
    ds_read_b64_tr_b16 v[72:73], v18 offset:0
    ds_read_b64_tr_b16 v[74:75], v18 offset:8192
    ds_read_b64_tr_b16 v[76:77], v19 offset:0
    ds_read_b64_tr_b16 v[78:79], v19 offset:8192
    ds_read_b64_tr_b16 v[80:81], v16 offset:16384
    ds_read_b64_tr_b16 v[82:83], v16 offset:24576
    ds_read_b64_tr_b16 v[84:85], v17 offset:16384
    ds_read_b64_tr_b16 v[86:87], v17 offset:24576
    ds_read_b64_tr_b16 v[88:89], v18 offset:16384
    ds_read_b64_tr_b16 v[90:91], v18 offset:24576
    ds_read_b64_tr_b16 v[92:93], v19 offset:16384
    ds_read_b64_tr_b16 v[94:95], v19 offset:24576
    ds_read_b64_tr_b16 v[96:97], v16 offset:32768
    ds_read_b64_tr_b16 v[98:99], v16 offset:40960
    ds_read_b64_tr_b16 v[100:101], v17 offset:32768
    ds_read_b64_tr_b16 v[102:103], v17 offset:40960
    ds_read_b64_tr_b16 v[104:105], v18 offset:32768
    ds_read_b64_tr_b16 v[106:107], v18 offset:40960
    ds_read_b64_tr_b16 v[108:109], v19 offset:32768
    ds_read_b64_tr_b16 v[110:111], v19 offset:40960
    buffer_load_dwordx4 v[48:51], v160, s[52:55], s86 offen sc1
    s_mov_b32 exec_hi, 0x00ffffff
    s_mov_b32 m0, s87
    s_add_u32 s87, s87, 928
    buffer_load_dwordx4 v161, s[96:99], s84 offen nt lds
    s_add_u32 s84, s84, 896

    s_mov_b32 m0, s87
    s_add_u32 s87, s87, 928
    buffer_load_dwordx4 v161, s[96:99], s84 offen nt lds
    s_add_u32 s84, s84, 896

    s_mov_b32 m0, s87
    s_add_u32 s87, s87, 928
    buffer_load_dwordx4 v161, s[96:99], s84 offen nt lds
    s_add_u32 s84, s84, 896

    s_mov_b32 exec_hi, -1
    s_and_b32 s13, s8, 1
    s_lshl_b32 s13, s13, 10
    v_lshl_add_u32 v177, v1, 7, s13
    s_mov_b64 exec, 0xff
    buffer_load_dword v176, v177, s[52:55], s85 offen nt
    s_mov_b64 exec, -1

    s_waitcnt lgkmcnt(15)
    v_mfma_f32_16x16x32_bf16 v[128:131], v[32:35], v[64:67], 0
    s_waitcnt lgkmcnt(15)
    v_mfma_f32_16x16x32_bf16 v[132:135], v[32:35], v[68:71], 0
    s_waitcnt lgkmcnt(15)
    v_mfma_f32_16x16x32_bf16 v[136:139], v[32:35], v[72:75], 0
    s_waitcnt lgkmcnt(15)
    v_mfma_f32_16x16x32_bf16 v[140:143], v[32:35], v[76:79], 0
    s_waitcnt lgkmcnt(14)
    v_mfma_f32_16x16x32_bf16 v[128:131], v[36:39], v[80:83], v[128:131]
    s_waitcnt lgkmcnt(12)
    v_mfma_f32_16x16x32_bf16 v[132:135], v[36:39], v[84:87], v[132:135]
    s_waitcnt lgkmcnt(10)
    v_mfma_f32_16x16x32_bf16 v[136:139], v[36:39], v[88:91], v[136:139]
    s_waitcnt lgkmcnt(8)
    v_mfma_f32_16x16x32_bf16 v[140:143], v[36:39], v[92:95], v[140:143]
    s_waitcnt lgkmcnt(6)
    v_mfma_f32_16x16x32_bf16 v[128:131], v[40:43], v[96:99], v[128:131]
    s_waitcnt lgkmcnt(4)
    v_mfma_f32_16x16x32_bf16 v[132:135], v[40:43], v[100:103], v[132:135]
    s_waitcnt lgkmcnt(2)
    v_mfma_f32_16x16x32_bf16 v[136:139], v[40:43], v[104:107], v[136:139]
    s_waitcnt lgkmcnt(0)
    v_mfma_f32_16x16x32_bf16 v[140:143], v[40:43], v[108:111], v[140:143]
    s_waitcnt vmcnt(6)
    s_barrier
    ds_read_b64_tr_b16 v[64:65], v16 offset:49152
    ds_read_b64_tr_b16 v[66:67], v16 offset:57344
    ds_read_b64_tr_b16 v[68:69], v17 offset:49152
    ds_read_b64_tr_b16 v[70:71], v17 offset:57344
    ds_read_b64_tr_b16 v[72:73], v18 offset:49152
    ds_read_b64_tr_b16 v[74:75], v18 offset:57344
    ds_read_b64_tr_b16 v[76:77], v19 offset:49152
    ds_read_b64_tr_b16 v[78:79], v19 offset:57344
    s_cmp_eq_u32 s43, 0
    s_waitcnt lgkmcnt(6)
    v_mfma_f32_16x16x32_bf16 v[128:131], v[44:47], v[64:67], v[128:131]
    s_waitcnt lgkmcnt(4)
    v_mfma_f32_16x16x32_bf16 v[132:135], v[44:47], v[68:71], v[132:135]
    s_waitcnt lgkmcnt(2)
    v_mfma_f32_16x16x32_bf16 v[136:139], v[44:47], v[72:75], v[136:139]
    s_waitcnt lgkmcnt(0)
    v_mfma_f32_16x16x32_bf16 v[140:143], v[44:47], v[76:79], v[140:143]
    s_nop 3
    v_cndmask_b32 v56, v128, v132, s[56:57]
    v_cndmask_b32 v57, v129, v133, s[56:57]
    v_cndmask_b32 v56, v56, v136, s[58:59]
    v_cndmask_b32 v57, v57, v137, s[58:59]
    v_cndmask_b32 v56, v56, v140, s[60:61]
    v_cndmask_b32 v57, v57, v141, s[60:61]
    s_nop 0
    v_mov_b32_dpp v58, v56 row_shl:8 row_mask:0xf bank_mask:0xf
    v_mov_b32_dpp v59, v57 row_shl:8 row_mask:0xf bank_mask:0xf
    s_mov_b32 exec_lo, 0x00ff00ff
    s_mov_b32 exec_hi, 0x00ff00ff
    v_bfi_b32 v56, v148, v4, v56
    v_bfi_b32 v57, v148, v149, v57
    v_bfi_b32 v58, v148, v150, v58
    v_bfi_b32 v59, v148, v151, v59

    s_cbranch_scc1 L_pub_far
    buffer_store_dwordx4 v[56:59], v15, s[52:55], s92 offen
L_pub_done:
    s_mov_b64 exec, -1
    v_mov_b32 v100, v179
    v_and_b32 v101, 0xff, v149
    v_mov_b32 v102, v150
    v_mov_b32 v103, v151

    buffer_load_dwordx4 v[32:35], v160, s[52:55], s85 offen offset:0 sc1
    buffer_load_dwordx4 v[36:39], v160, s[52:55], s85 offen offset:1024 sc1
    s_mov_b32 s15, 0
    s_mov_b64 s[20:21], -1
    s_mov_b64 s[22:23], -1
    s_waitcnt vmcnt(7)
    v_perm_b32 v153, v49, v48, v152
    v_perm_b32 v154, v51, v50, v152
    v_lshl_or_b32 v153, v154, 16, v153
    v_cmp_ne_u32 s[16:17], v4, v153
    s_nop 1
    s_or_b64 vcc, s[16:17], 0
    s_cbranch_scc0 L_w
    s_or_b64 exec, s[16:17], 1
    buffer_load_dwordx4 v[48:51], v160, s[52:55], s86 offen sc1
    s_mov_b64 exec, -1
    s_mov_b32 s15, 1
    s_waitcnt vmcnt(4)
    buffer_load_dwordx4 v[180:183], v160, s[52:55], s85 offen offset:0 sc1
    buffer_load_dwordx4 v[184:187], v160, s[52:55], s85 offen offset:1024 sc1
    s_barrier
    ds_read_b64 v[170:171], v175
    ds_read_b64 v[172:173], v175 offset:16
    ds_read_b64_tr_b16 v[64:65], v162 offset:0
    ds_read_b64_tr_b16 v[66:67], v162 offset:448
    ds_read_b64_tr_b16 v[68:69], v162 offset:32
    ds_read_b64_tr_b16 v[70:71], v162 offset:480
    ds_read_b64_tr_b16 v[72:73], v162 offset:64
    ds_read_b64_tr_b16 v[74:75], v162 offset:512
    ds_read_b64_tr_b16 v[76:77], v162 offset:96
    ds_read_b64_tr_b16 v[78:79], v162 offset:544
    ds_read_b64_tr_b16 v[80:81], v162 offset:128
    ds_read_b64_tr_b16 v[82:83], v162 offset:576
    ds_read_b64_tr_b16 v[84:85], v162 offset:160
    ds_read_b64_tr_b16 v[86:87], v162 offset:608
    ds_read_b64_tr_b16 v[88:89], v162 offset:192
    ds_read_b64_tr_b16 v[90:91], v162 offset:640
    s_waitcnt vmcnt(2)
    v_perm_b32 v153, v49, v48, v152
    v_perm_b32 v154, v51, v50, v152
    v_lshl_or_b32 v153, v154, 16, v153
    v_cmp_ne_u32 vcc, v4, v153
    s_mov_b64 s[16:17], -1
    s_mov_b64 s[18:19], -1
    s_cbranch_vccz L_w
L_sl:
    s_nop 0
    s_mov_b64 exec, vcc
    buffer_load_dwordx4 v[48:51], v160, s[52:55], s86 offen sc1
    s_mov_b64 exec, -1
    s_sub_u32 s42, s42, 1
    s_cmp_gt_i32 s42, 0
    s_waitcnt vmcnt(0)
    s_cbranch_scc0 L_sl_out

    v_perm_b32 v153, v49, v48, v152
    v_perm_b32 v154, v51, v50, v152
    v_lshl_or_b32 v153, v154, 16, v153
    v_cmp_ne_u32 vcc, v4, v153
    s_nop 1
    s_cbranch_vccnz L_sl
L_sl_out:
    s_mov_b32 s15, 2
L_ra:
    v_perm_b32 v153, v33, v32, v152
    v_perm_b32 v154, v35, v34, v152
    v_perm_b32 v155, v37, v36, v152
    v_perm_b32 v178, v39, v38, v152
    v_lshl_or_b32 v153, v154, 16, v153
    v_lshl_or_b32 v155, v178, 16, v155
    v_cmp_ne_u32 s[20:21], v4, v153
    v_cmp_ne_u32 s[22:23], v4, v155
    s_nop 0
    s_or_b64 exec, s[20:21], 1
    buffer_load_dwordx4 v[32:35], v160, s[52:55], s85 offen offset:0 sc1
    s_or_b64 exec, s[22:23], 1
    buffer_load_dwordx4 v[36:39], v160, s[52:55], s85 offen offset:1024 sc1
    s_mov_b64 exec, -1
L_w:
    v_and_b32 v60, 0xffffff00, v50
    v_and_b32 v48, 0xffffff00, v48
    v_and_b32 v62, 0xffffff00, v51
    v_and_b32 v50, 0xffffff00, v49
    v_mov_b32 v52, v48
    v_mov_b32 v53, v60
    s_nop 0
    v_max_f32_dpp v52, v52, v52 row_ror:4 row_mask:0xf bank_mask:0xf
    v_max_f32_dpp v53, v53, v53 row_ror:4 row_mask:0xf bank_mask:0xf
    s_nop 0
    v_max_f32_dpp v52, v52, v52 row_ror:8 row_mask:0xf bank_mask:0xf
    v_max_f32_dpp v53, v53, v53 row_ror:8 row_mask:0xf bank_mask:0xf
    v_mov_b32 v54, v52
    v_mov_b32 v55, v53
    s_nop 0
    v_permlane16_swap_b32 v52, v54
    v_permlane16_swap_b32 v53, v55
    v_max_f32 v52, v52, v54
    v_max_f32 v53, v53, v55
    v_mov_b32 v54, v52
    v_mov_b32 v55, v53
    s_nop 0
    v_permlane32_swap_b32 v52, v54
    v_permlane32_swap_b32 v53, v55
    v_max_f32 v52, v52, v54
    v_max_f32 v53, v53, v55
    v_sub_f32 v48, v48, v52
    v_sub_f32 v60, v60, v53
    v_exp_f32 v48, v48
    v_exp_f32 v60, v60
    v_mul_f32 v50, v48, v50
    v_mul_f32 v62, v60, v62

    s_nop 0
    v_add_f32_dpp v50, v50, v50 row_ror:1 row_mask:0xf bank_mask:0xf
    v_add_f32_dpp v62, v62, v62 row_ror:1 row_mask:0xf bank_mask:0xf
    s_nop 0
    v_add_f32_dpp v50, v50, v50 row_ror:2 row_mask:0xf bank_mask:0xf
    v_add_f32_dpp v62, v62, v62 row_ror:2 row_mask:0xf bank_mask:0xf
    s_nop 0
    v_add_f32_dpp v50, v50, v50 row_ror:4 row_mask:0xf bank_mask:0xf
    v_add_f32_dpp v62, v62, v62 row_ror:4 row_mask:0xf bank_mask:0xf
    s_nop 0
    v_add_f32_dpp v50, v50, v50 row_ror:8 row_mask:0xf bank_mask:0xf
    v_add_f32_dpp v62, v62, v62 row_ror:8 row_mask:0xf bank_mask:0xf
    v_mov_b32 v54, v50
    v_mov_b32 v55, v62
    s_nop 0
    v_permlane16_swap_b32 v50, v54
    v_permlane16_swap_b32 v62, v55
    v_add_f32 v50, v50, v54
    v_add_f32 v62, v62, v55
    v_mov_b32 v54, v50
    v_mov_b32 v55, v62
    s_nop 0
    v_permlane32_swap_b32 v50, v54
    v_permlane32_swap_b32 v62, v55
    v_add_f32 v50, v50, v54
    v_add_f32 v62, v62, v55
    v_rcp_f32 v50, v50
    v_rcp_f32 v62, v62
    v_mul_f32 v48, v48, v50
    v_mul_f32 v60, v60, v62

    v_mov_b32 v122, v48
    v_mov_b32 v123, v60
    v_mov_b32 v120, v48
    v_mov_b32 v121, v60
    v_mov_b32_dpp v122, v48 row_shl:4 row_mask:0xf bank_mask:0x5
    v_mov_b32_dpp v123, v60 row_shl:4 row_mask:0xf bank_mask:0x5
    v_mov_b32_dpp v120, v48 row_shr:4 row_mask:0xf bank_mask:0xa
    v_mov_b32_dpp v121, v60 row_shr:4 row_mask:0xf bank_mask:0xa

    s_cmp_eq_u32 s15, 1
    s_cbranch_scc1 L_o_chk
    s_cmp_eq_u32 s15, 2
    s_cbranch_scc1 L_pb

    s_waitcnt vmcnt(3)
L_pb:

    s_or_b64 exec, s[20:21], 1
    buffer_load_dwordx4 v[180:183], v160, s[52:55], s85 offen offset:0 sc1
    s_or_b64 exec, s[22:23], 1
    buffer_load_dwordx4 v[184:187], v160, s[52:55], s85 offen offset:1024 sc1
    s_mov_b64 exec, -1
    s_mov_b64 s[16:17], s[20:21]
    s_mov_b64 s[18:19], s[22:23]
    s_cmp_eq_u32 s15, 2
    s_cbranch_scc1 L_pc2
    s_barrier
    ds_read_b64 v[170:171], v175
    ds_read_b64 v[172:173], v175 offset:16
    ds_read_b64_tr_b16 v[64:65], v162 offset:0
    ds_read_b64_tr_b16 v[66:67], v162 offset:448
    ds_read_b64_tr_b16 v[68:69], v162 offset:32
    ds_read_b64_tr_b16 v[70:71], v162 offset:480
    ds_read_b64_tr_b16 v[72:73], v162 offset:64
    ds_read_b64_tr_b16 v[74:75], v162 offset:512
    ds_read_b64_tr_b16 v[76:77], v162 offset:96
    ds_read_b64_tr_b16 v[78:79], v162 offset:544
    ds_read_b64_tr_b16 v[80:81], v162 offset:128
    ds_read_b64_tr_b16 v[82:83], v162 offset:576
    ds_read_b64_tr_b16 v[84:85], v162 offset:160
    ds_read_b64_tr_b16 v[86:87], v162 offset:608
    ds_read_b64_tr_b16 v[88:89], v162 offset:192
    ds_read_b64_tr_b16 v[90:91], v162 offset:640
L_pc2:
    s_waitcnt vmcnt(2)
L_o_chk:
    v_perm_b32 v153, v33, v32, v152
    v_perm_b32 v154, v35, v34, v152
    v_perm_b32 v155, v37, v36, v152
    v_perm_b32 v178, v39, v38, v152
    v_lshl_or_b32 v153, v154, 16, v153
    v_lshl_or_b32 v155, v178, 16, v155
    v_cmp_ne_u32 s[20:21], v4, v153
    v_cmp_ne_u32 s[22:23], v4, v155
    s_nop 1
    s_or_b64 vcc, s[20:21], s[22:23]
    s_cbranch_scc0 L_o_ok
    s_and_b64 s[16:17], s[16:17], s[20:21]
    s_and_b64 s[18:19], s[18:19], s[22:23]
    s_or_b64 vcc, s[16:17], s[18:19]
    s_cbranch_scc0 L_o_mrg
    s_or_b64 exec, s[16:17], 1
    buffer_load_dwordx4 v[32:35], v160, s[52:55], s85 offen offset:0 sc1
    s_or_b64 exec, s[18:19], 1
    buffer_load_dwordx4 v[36:39], v160, s[52:55], s85 offen offset:1024 sc1
    s_mov_b64 exec, -1
    s_waitcnt vmcnt(2)
L_o_midb:
    v_perm_b32 v153, v181, v180, v152
    v_perm_b32 v154, v183, v182, v152
    v_perm_b32 v155, v185, v184, v152
    v_perm_b32 v178, v187, v186, v152
    v_lshl_or_b32 v153, v154, 16, v153
    v_lshl_or_b32 v155, v178, 16, v155
    v_cmp_ne_u32 s[16:17], v4, v153
    v_cmp_ne_u32 s[18:19], v4, v155
    s_nop 0
    s_and_b64 s[16:17], s[16:17], s[20:21]
    s_and_b64 s[18:19], s[18:19], s[22:23]
    s_or_b64 vcc, s[16:17], s[18:19]
    s_cbranch_scc0 L_o_mrg
    s_or_b64 exec, s[16:17], 1
    buffer_load_dwordx4 v[180:183], v160, s[52:55], s85 offen offset:0 sc1
    s_or_b64 exec, s[18:19], 1
    buffer_load_dwordx4 v[184:187], v160, s[52:55], s85 offen offset:1024 sc1
    s_mov_b64 exec, -1
    s_waitcnt vmcnt(2)
    s_sub_u32 s42, s42, 1
    s_cmp_gt_i32 s42, 0
    s_cbranch_scc1 L_o_chk
L_o_mrg:

    v_cndmask_b32 v32, v32, v180, s[20:21]
    v_cndmask_b32 v33, v33, v181, s[20:21]
    v_cndmask_b32 v34, v34, v182, s[20:21]
    v_cndmask_b32 v35, v35, v183, s[20:21]
    v_cndmask_b32 v36, v36, v184, s[22:23]
    v_cndmask_b32 v37, v37, v185, s[22:23]
    v_cndmask_b32 v38, v38, v186, s[22:23]
    v_cndmask_b32 v39, v39, v187, s[22:23]
L_o_ok:
    v_and_b32 v40, 0xffffff00, v32
    v_and_b32 v41, 0xffffff00, v33
    v_and_b32 v42, 0xffffff00, v34
    v_and_b32 v43, 0xffffff00, v35
    v_and_b32 v44, 0xffffff00, v36
    v_and_b32 v45, 0xffffff00, v37
    v_and_b32 v46, 0xffffff00, v38
    v_and_b32 v47, 0xffffff00, v39
    s_waitcnt lgkmcnt(0)
    v_bfi_b32 v170, v148, v4, v170
    v_bfi_b32 v171, v148, v149, v171
    v_bfi_b32 v172, v148, v150, v172
    v_bfi_b32 v173, v148, v151, v173
    s_barrier
    s_mov_b64 exec, s[44:45]
    buffer_store_dwordx4 v[170:173], v164, s[52:55], s32 offen sc1
    s_mov_b64 exec, -1

    v_pk_mul_f32 v[92:93], v[40:41], v[120:121]
    v_pk_mul_f32 v[94:95], v[42:43], v[120:121]
    v_pk_fma_f32 v[92:93], v[44:45], v[122:123], v[92:93]
    v_pk_fma_f32 v[94:95], v[46:47], v[122:123], v[94:95]

    s_nop 0
    v_add_f32_dpp v136, v92, v92 row_ror:8 row_mask:0xf bank_mask:0x3
    v_add_f32_dpp v137, v93, v93 row_ror:8 row_mask:0xf bank_mask:0x3
    v_add_f32_dpp v136, v94, v94 row_ror:8 row_mask:0xf bank_mask:0xc
    v_add_f32_dpp v137, v95, v95 row_ror:8 row_mask:0xf bank_mask:0xc
    s_nop 0
    v_mfma_f32_16x16x4_f32 v[128:131], v136, v144, 0
    v_mfma_f32_16x16x4_f32 v[132:135], v137, v144, 0

    s_cmp_eq_u32 s46, 0
    s_waitcnt lgkmcnt(0)

    s_nop 8
    v_cvt_pk_bf16_f32 v140, v128, v129
    v_cvt_pk_bf16_f32 v141, v130, v131
    v_cvt_pk_bf16_f32 v142, v132, v133
    v_cvt_pk_bf16_f32 v143, v134, v135
    s_nop 1
    v_mfma_f32_16x16x32_bf16 v[196:199], v[140:143], v[64:67], 0
    v_mfma_f32_16x16x32_bf16 v[200:203], v[140:143], v[68:71], 0
    v_mfma_f32_16x16x32_bf16 v[204:207], v[140:143], v[72:75], 0
    v_mfma_f32_16x16x32_bf16 v[208:211], v[140:143], v[76:79], 0
    v_mfma_f32_16x16x32_bf16 v[212:215], v[140:143], v[80:83], 0
    v_mfma_f32_16x16x32_bf16 v[216:219], v[140:143], v[84:87], 0
    v_mfma_f32_16x16x32_bf16 v[220:223], v[140:143], v[88:91], 0
    s_nop 2
    v_cndmask_b32 v156, v196, v200, s[56:57]
    v_cndmask_b32 v156, v156, v204, s[58:59]
    v_cndmask_b32 v156, v156, v208, s[60:61]
    s_nop 0
    v_cndmask_b32 v157, v212, v216, s[56:57]
    v_cndmask_b32 v157, v157, v220, s[58:59]

    v_mov_b32_dpp v158, v156 quad_perm:[2,3,2,3] row_mask:0xf bank_mask:0xf
    v_bfi_b32 v156, v148, v4, v156
    v_mov_b32_dpp v159, v157 quad_perm:[2,3,2,3] row_mask:0xf bank_mask:0xf
    s_mov_b32 exec_lo, 0x33333333
    s_mov_b32 exec_hi, 0x33333333
    v_bfi_b32 v157, v148, v149, v157
    v_bfi_b32 v158, v148, v150, v158
    v_bfi_b32 v159, v148, v151, v159

    buffer_store_dwordx4 v[156:159], v163, s[52:55], s88 offen sc1
    s_mov_b64 exec, -1
    s_cbranch_scc1 L_done
    s_add_u32 s43, s9, 4096
    s_add_u32 s48, s90, 8192
    s_add_u32 s49, s90, 12288
    s_mov_b32 s60, 0xcccccccc
    s_mov_b32 s61, 0xcccccccc
    s_mov_b32 s62, 0xf0f0f0f0
    s_mov_b32 s63, 0xf0f0f0f0
    v_lshlrev_b32 v167, 16, v167
    v_lshlrev_b32 v168, 16, v168
    s_cmp_lt_u32 s7, 12
    s_cselect_b32 s14, 0xff, 0xf

    s_mov_b32 s15, 0
    s_waitcnt vmcnt(0)
    buffer_load_dwordx4 v[96:99], v160, s[52:55], s9 offen offset:0 sc1
    s_mov_b32 exec_hi, 0xffff
    buffer_load_dwordx4 v[100:103], v160, s[52:55], s9 offen offset:1024 sc1
    s_mov_b32 exec_hi, -1
    s_waitcnt vmcnt(0)
L_f_chk:
    v_perm_b32 v112, v97, v96, v152
    v_perm_b32 v113, v99, v98, v152
    v_perm_b32 v114, v101, v100, v152
    v_perm_b32 v115, v103, v102, v152
    v_lshl_or_b32 v112, v113, 16, v112
    v_lshl_or_b32 v114, v115, 16, v114
    v_cmp_ne_u32 s[16:17], v4, v112
    v_cmp_ne_u32 s[18:19], v4, v114
    s_nop 1
    s_or_b64 vcc, s[16:17], s[18:19]
    s_cbranch_scc0 L_f_ok
    s_sub_u32 s42, s42, 1
    s_cmp_gt_i32 s42, 0
    s_cbranch_scc0 L_f_ok

    s_mov_b64 exec, s[16:17]
    buffer_load_dwordx4 v[96:99], v160, s[52:55], s9 offen offset:0 sc1
    s_mov_b64 exec, s[18:19]
    buffer_load_dwordx4 v[100:103], v160, s[52:55], s9 offen offset:1024 sc1
    s_mov_b64 exec, -1
    s_waitcnt vmcnt(0)
    s_branch L_f_chk
L_f_ok:
    buffer_load_dwordx4 v[36:39], v145, s[52:55], s90 offen sc1
    buffer_load_dwordx4 v[40:43], v145, s[52:55], s93 offen sc1
    buffer_load_dwordx4 v[44:47], v145, s[52:55], s48 offen sc1
    buffer_load_dwordx4 v[48:51], v145, s[52:55], s49 offen sc1
L_noS:
    v_and_b32 v96, 0xffffff00, v96
    v_and_b32 v97, 0xffffff00, v97
    v_and_b32 v98, 0xffffff00, v98
    v_and_b32 v99, 0xffffff00, v99
    v_and_b32 v100, 0xffffff00, v100
    v_and_b32 v101, 0xffffff00, v101
    v_and_b32 v102, 0xffffff00, v102
    v_and_b32 v103, 0xffffff00, v103
    v_pk_add_f32 v[96:97], v[96:97], v[100:101]
    v_pk_add_f32 v[98:99], v[98:99], v[102:103]
    v_cndmask_b32 v100, v98, v96, s[60:61]
    v_cndmask_b32 v101, v99, v97, s[60:61]
    v_cndmask_b32 v96, v96, v98, s[60:61]
    v_cndmask_b32 v97, v97, v99, s[60:61]
    v_add_f32_dpp v96, v100, v96 quad_perm:[2,3,0,1] row_mask:0xf bank_mask:0xf
    v_add_f32_dpp v98, v101, v97 quad_perm:[2,3,0,1] row_mask:0xf bank_mask:0xf

    v_cndmask_b32 v97, v98, v96, s[62:63]
    v_cndmask_b32 v96, v96, v98, s[62:63]
    s_nop 0
    v_add_f32_dpp v96, v97, v96 row_ror:4 row_mask:0xf bank_mask:0xf
    s_nop 1
    v_add_f32_dpp v96, v96, v96 row_ror:8 row_mask:0xf bank_mask:0xf

    v_mov_b32 v97, v96
    s_nop 1
    v_permlane16_swap_b32 v96, v97
    v_add_f32 v96, v96, v97
    v_mov_b32 v97, v96
    s_nop 1
    v_permlane32_swap_b32 v96, v97
    v_add_f32 v96, v96, v97
    v_cvt_pk_bf16_f32 v96, v96, v96
    v_lshlrev_b32 v96, 16, v96
    v_add_f32 v96, v96, v168
    v_cvt_pk_bf16_f32 v96, v96, v96
    v_lshlrev_b32 v96, 16, v96
    v_mul_f32 v97, 0xbfb8aa3b, v96
    v_exp_f32 v97, v97
    s_nop 0
    v_add_f32 v97, 1.0, v97
    v_rcp_f32 v97, v97
    s_nop 0
    v_mul_f32 v96, v96, v97

    v_cvt_pk_bf16_f32 v96, v96, v96
    v_lshlrev_b32 v96, 16, v96
    s_waitcnt vmcnt(0)
L_s_chk:
    v_perm_b32 v112, v37, v36, v152
    v_perm_b32 v113, v39, v38, v152
    v_perm_b32 v114, v41, v40, v152
    v_perm_b32 v115, v43, v42, v152
    v_perm_b32 v116, v45, v44, v152
    v_perm_b32 v117, v47, v46, v152
    v_perm_b32 v118, v49, v48, v152
    v_perm_b32 v119, v51, v50, v152
    v_lshl_or_b32 v112, v113, 16, v112
    v_lshl_or_b32 v114, v115, 16, v114
    v_lshl_or_b32 v116, v117, 16, v116
    v_lshl_or_b32 v118, v119, 16, v118
    v_cmp_ne_u32 s[16:17], v4, v112
    v_cmp_ne_u32 s[18:19], v4, v114
    v_cmp_ne_u32 s[20:21], v4, v116
    v_cmp_ne_u32 s[22:23], v4, v118
    s_or_b64 vcc, s[16:17], s[18:19]
    s_or_b64 vcc, vcc, s[20:21]
    s_or_b64 vcc, vcc, s[22:23]
    s_cbranch_scc0 L_s_ok
    s_sub_u32 s42, s42, 1
    s_cmp_gt_i32 s42, 0
    s_cbranch_scc0 L_s_ok

    s_mov_b64 exec, s[16:17]
    buffer_load_dwordx4 v[36:39], v145, s[52:55], s90 offen sc1
    s_mov_b64 exec, s[18:19]
    buffer_load_dwordx4 v[40:43], v145, s[52:55], s93 offen sc1
    s_mov_b64 exec, s[20:21]
    buffer_load_dwordx4 v[44:47], v145, s[52:55], s48 offen sc1
    s_mov_b64 exec, s[22:23]
    buffer_load_dwordx4 v[48:51], v145, s[52:55], s49 offen sc1
    s_mov_b64 exec, -1
    s_waitcnt vmcnt(0)
    s_branch L_s_chk
L_s_ok:
    v_and_b32 v36, 0xffffff00, v36
    v_and_b32 v37, 0xffffff00, v37
    v_and_b32 v38, 0xffffff00, v38
    v_and_b32 v39, 0xffffff00, v39
    v_and_b32 v40, 0xffffff00, v40
    v_and_b32 v41, 0xffffff00, v41
    v_and_b32 v42, 0xffffff00, v42
    v_and_b32 v43, 0xffffff00, v43
    v_and_b32 v44, 0xffffff00, v44
    v_and_b32 v45, 0xffffff00, v45
    v_and_b32 v46, 0xffffff00, v46
    v_and_b32 v47, 0xffffff00, v47
    v_and_b32 v48, 0xffffff00, v48
    v_and_b32 v49, 0xffffff00, v49
    v_and_b32 v50, 0xffffff00, v50
    v_and_b32 v51, 0xffffff00, v51
    v_pk_add_f32 v[36:37], v[36:37], v[44:45]
    v_pk_add_f32 v[38:39], v[38:39], v[46:47]
    v_pk_add_f32 v[40:41], v[40:41], v[48:49]
    v_pk_add_f32 v[42:43], v[42:43], v[50:51]
    v_pk_add_f32 v[36:37], v[36:37], v[40:41]
    v_pk_add_f32 v[38:39], v[38:39], v[42:43]
    v_cndmask_b32 v40, v38, v36, s[60:61]
    v_cndmask_b32 v41, v39, v37, s[60:61]
    v_cndmask_b32 v36, v36, v38, s[60:61]
    v_cndmask_b32 v37, v37, v39, s[60:61]
    v_add_f32_dpp v36, v40, v36 quad_perm:[2,3,0,1] row_mask:0xf bank_mask:0xf
    v_add_f32_dpp v38, v41, v37 quad_perm:[2,3,0,1] row_mask:0xf bank_mask:0xf

    v_cndmask_b32 v37, v38, v36, s[62:63]
    v_cndmask_b32 v36, v36, v38, s[62:63]
    s_nop 0
    v_add_f32_dpp v36, v37, v36 row_ror:4 row_mask:0xf bank_mask:0xf
    s_nop 1
    v_add_f32_dpp v36, v36, v36 row_ror:8 row_mask:0xf bank_mask:0xf

    v_mov_b32 v37, v36
    s_nop 1
    v_permlane16_swap_b32 v36, v37
    v_add_f32 v36, v36, v37
    v_mov_b32 v37, v36
    s_nop 1
    v_permlane32_swap_b32 v36, v37
    v_add_f32 v36, v36, v37
    v_cvt_pk_bf16_f32 v36, v36, v36
    v_lshlrev_b32 v36, 16, v36
    v_mul_f32 v36, v36, v96
    v_cvt_pk_bf16_f32 v36, v36, v36
    v_lshlrev_b32 v36, 16, v36
    v_add_f32 v36, v36, v167
    s_cmp_eq_u32 s89, 0
    v_cvt_pk_bf16_f32 v36, v36, v36
    s_mov_b64 exec, s[14:15]
    global_store_short v165, v36, s[36:37]
    s_cbranch_scc0 L_done
    s_mov_b64 exec, 1
    buffer_store_dword v4, off, s[52:55], 0

L_done:
L_end:
    s_endpgm
L_p1:
    s_cbranch_vccz L_o_ok
    s_waitcnt vmcnt(4)
    s_branch L_o_midb
L_st_far:
    buffer_store_dwordx4 v[52:55], v169, s[52:55], s91 offen sc1
    s_branch L_st_done
L_pub_far:
    buffer_store_dwordx4 v[56:59], v15, s[52:55], s92 offen sc1
    s_branch L_pub_done

L_aux2:
    v_mov_b32 v40, 0
    v_mov_b32 v41, 0
    v_mov_b32 v42, 0
    v_mov_b32 v43, 0
    v_mov_b32 v44, 0
    v_mov_b32 v45, 0
    v_mov_b32 v46, 0
    v_mov_b32 v47, 0
    v_mov_b32 v48, 0
    v_mov_b32 v49, 0
    v_mov_b32 v50, 0
    v_mov_b32 v51, 0
    v_mov_b32 v52, 0
    v_mov_b32 v53, 0
    v_mov_b32 v54, 0
    v_mov_b32 v55, 0
    v_mov_b32 v56, 0
    v_mov_b32 v57, 0
    s_mov_b32 exec_hi, 0x00ffffff
    s_waitcnt vmcnt(25)
    v_lshlrev_b32 v40, 16, v8
    v_and_b32 v41, 0xffff0000, v8
    v_lshlrev_b32 v42, 16, v9
    v_and_b32 v43, 0xffff0000, v9
    v_lshlrev_b32 v44, 16, v10
    v_and_b32 v45, 0xffff0000, v10
    v_lshlrev_b32 v46, 16, v11
    v_and_b32 v47, 0xffff0000, v11
    s_mov_b32 exec_hi, -1
    s_mov_b32 exec_lo, 0xffffff00
    v_lshlrev_b32 v48, 16, v12
    v_and_b32 v49, 0xffff0000, v12
    v_lshlrev_b32 v50, 16, v13
    v_and_b32 v51, 0xffff0000, v13
    v_lshlrev_b32 v52, 16, v14
    v_and_b32 v53, 0xffff0000, v14
    v_lshlrev_b32 v54, 16, v15
    v_and_b32 v55, 0xffff0000, v15
    s_mov_b32 exec_lo, -1
    v_add_f32 v36, v40, v41
    v_add_f32 v37, v48, v49
    v_add_f32 v36, v36, v42
    v_add_f32 v37, v37, v50
    v_add_f32 v36, v36, v43
    v_add_f32 v37, v37, v51
    v_add_f32 v36, v36, v44
    v_add_f32 v37, v37, v52
    v_add_f32 v36, v36, v45
    v_add_f32 v37, v37, v53
    v_add_f32 v36, v36, v46
    v_add_f32 v37, v37, v54
    v_add_f32 v36, v36, v47
    v_add_f32 v37, v37, v55
    s_nop 0
    v_add_f32_dpp v36, v36, v36 row_ror:8 row_mask:0xf bank_mask:0xf
    v_add_f32_dpp v37, v37, v37 row_ror:8 row_mask:0xf bank_mask:0xf
    s_nop 0
    v_add_f32_dpp v36, v36, v36 row_ror:4 row_mask:0xf bank_mask:0xf
    v_add_f32_dpp v37, v37, v37 row_ror:4 row_mask:0xf bank_mask:0xf
    s_nop 0
    v_add_f32_dpp v36, v36, v36 row_ror:2 row_mask:0xf bank_mask:0xf
    v_add_f32_dpp v37, v37, v37 row_ror:2 row_mask:0xf bank_mask:0xf
    s_nop 0
    v_add_f32_dpp v36, v36, v36 row_ror:1 row_mask:0xf bank_mask:0xf
    v_add_f32_dpp v37, v37, v37 row_ror:1 row_mask:0xf bank_mask:0xf
    v_mov_b32 v38, v36
    v_mov_b32 v39, v37
    s_nop 0
    v_permlane16_swap_b32 v36, v38
    v_permlane16_swap_b32 v37, v39
    v_add_f32 v36, v36, v38
    v_add_f32 v37, v37, v39
    v_mov_b32 v38, v36
    v_mov_b32 v39, v37
    s_nop 0
    v_permlane32_swap_b32 v36, v38
    v_permlane32_swap_b32 v37, v39
    v_add_f32 v36, v36, v38
    v_add_f32 v37, v37, v39
    v_mul_f32 v36, 0x3b124925, v36
    v_mul_f32 v37, 0x3b124925, v37

    v_sub_f32 v58, v40, v36
    v_sub_f32 v59, v48, v37
    v_fmac_f32 v56, v58, v58
    v_fmac_f32 v57, v59, v59
    v_sub_f32 v58, v41, v36
    v_sub_f32 v59, v49, v37
    v_fmac_f32 v56, v58, v58
    v_fmac_f32 v57, v59, v59
    v_sub_f32 v58, v42, v36
    v_sub_f32 v59, v50, v37
    v_fmac_f32 v56, v58, v58
    v_fmac_f32 v57, v59, v59
    v_sub_f32 v58, v43, v36
    v_sub_f32 v59, v51, v37
    v_fmac_f32 v56, v58, v58
    v_fmac_f32 v57, v59, v59
    v_sub_f32 v58, v44, v36
    v_sub_f32 v59, v52, v37
    v_fmac_f32 v56, v58, v58
    v_fmac_f32 v57, v59, v59
    v_sub_f32 v58, v45, v36
    v_sub_f32 v59, v53, v37
    v_fmac_f32 v56, v58, v58
    v_fmac_f32 v57, v59, v59
    v_sub_f32 v58, v46, v36
    v_sub_f32 v59, v54, v37
    v_fmac_f32 v56, v58, v58
    v_fmac_f32 v57, v59, v59
    v_sub_f32 v58, v47, v36
    v_sub_f32 v59, v55, v37
    v_fmac_f32 v56, v58, v58
    v_fmac_f32 v57, v59, v59
    s_mov_b32 exec_lo, 0xff
    s_mov_b32 exec_hi, 0
    v_mov_b32 v57, 0
    s_mov_b32 exec_lo, 0
    s_mov_b32 exec_hi, 0xff000000
    v_mov_b32 v56, 0
    s_mov_b64 exec, -1

    s_nop 1
    v_add_f32_dpp v56, v56, v56 row_ror:8 row_mask:0xf bank_mask:0xf
    v_add_f32_dpp v57, v57, v57 row_ror:8 row_mask:0xf bank_mask:0xf
    s_nop 0
    v_add_f32_dpp v56, v56, v56 row_ror:4 row_mask:0xf bank_mask:0xf
    v_add_f32_dpp v57, v57, v57 row_ror:4 row_mask:0xf bank_mask:0xf
    s_nop 0
    v_add_f32_dpp v56, v56, v56 row_ror:2 row_mask:0xf bank_mask:0xf
    v_add_f32_dpp v57, v57, v57 row_ror:2 row_mask:0xf bank_mask:0xf
    s_nop 0
    v_add_f32_dpp v56, v56, v56 row_ror:1 row_mask:0xf bank_mask:0xf
    v_add_f32_dpp v57, v57, v57 row_ror:1 row_mask:0xf bank_mask:0xf
    v_mov_b32 v38, v56
    v_mov_b32 v39, v57
    s_nop 0
    v_permlane16_swap_b32 v56, v38
    v_permlane16_swap_b32 v57, v39
    v_add_f32 v56, v56, v38
    v_add_f32 v57, v57, v39
    v_mov_b32 v38, v56
    v_mov_b32 v39, v57
    s_nop 0
    v_permlane32_swap_b32 v56, v38
    v_permlane32_swap_b32 v57, v39
    v_add_f32 v56, v56, v38
    v_add_f32 v57, v57, v39
    v_mul_f32 v56, 0x3b124925, v56
    v_mul_f32 v57, 0x3b124925, v57
    v_cvt_pk_bf16_f32 v38, v56, v57
    v_cvt_pk_bf16_f32 v39, v36, v37
    v_lshlrev_b32 v56, 16, v38
    v_and_b32 v57, 0xffff0000, v38
    v_lshlrev_b32 v36, 16, v39
    v_and_b32 v37, 0xffff0000, v39
    v_add_f32 v56, 0x3727c5ac, v56
    v_add_f32 v57, 0x3727c5ac, v57
    v_cvt_pk_bf16_f32 v38, v56, v57
    v_lshlrev_b32 v56, 16, v38
    v_and_b32 v57, 0xffff0000, v38
    v_sqrt_f32 v56, v56
    v_sqrt_f32 v57, v57
    s_nop 0
    v_cvt_pk_bf16_f32 v38, v56, v57
    v_lshlrev_b32 v56, 16, v38
    v_and_b32 v57, 0xffff0000, v38
    v_rcp_f32 v56, v56
    v_rcp_f32 v57, v57
    v_sub_f32 v40, v40, v36
    v_sub_f32 v48, v48, v37
    v_sub_f32 v41, v41, v36
    v_sub_f32 v49, v49, v37
    v_sub_f32 v42, v42, v36
    v_sub_f32 v50, v50, v37
    v_sub_f32 v43, v43, v36
    v_sub_f32 v51, v51, v37
    v_sub_f32 v44, v44, v36
    v_sub_f32 v52, v52, v37
    v_sub_f32 v45, v45, v36
    v_sub_f32 v53, v53, v37
    v_sub_f32 v46, v46, v36
    v_sub_f32 v54, v54, v37
    v_sub_f32 v47, v47, v36
    v_sub_f32 v55, v55, v37
    v_cvt_pk_bf16_f32 v60, v40, v41
    v_cvt_pk_bf16_f32 v61, v42, v43
    v_cvt_pk_bf16_f32 v62, v44, v45
    v_cvt_pk_bf16_f32 v63, v46, v47
    v_cvt_pk_bf16_f32 v64, v48, v49
    v_cvt_pk_bf16_f32 v65, v50, v51
    v_cvt_pk_bf16_f32 v66, v52, v53
    v_cvt_pk_bf16_f32 v67, v54, v55
    v_lshlrev_b32 v40, 16, v60
    v_and_b32 v41, 0xffff0000, v60
    v_lshlrev_b32 v42, 16, v61
    v_and_b32 v43, 0xffff0000, v61
    v_lshlrev_b32 v44, 16, v62
    v_and_b32 v45, 0xffff0000, v62
    v_lshlrev_b32 v46, 16, v63
    v_and_b32 v47, 0xffff0000, v63
    v_lshlrev_b32 v48, 16, v64
    v_and_b32 v49, 0xffff0000, v64
    v_lshlrev_b32 v50, 16, v65
    v_and_b32 v51, 0xffff0000, v65
    v_lshlrev_b32 v52, 16, v66
    v_and_b32 v53, 0xffff0000, v66
    v_lshlrev_b32 v54, 16, v67
    v_and_b32 v55, 0xffff0000, v67
    v_mul_f32 v40, v40, v56
    v_mul_f32 v48, v48, v57
    v_mul_f32 v41, v41, v56
    v_mul_f32 v49, v49, v57
    v_mul_f32 v42, v42, v56
    v_mul_f32 v50, v50, v57
    v_mul_f32 v43, v43, v56
    v_mul_f32 v51, v51, v57
    v_mul_f32 v44, v44, v56
    v_mul_f32 v52, v52, v57
    v_mul_f32 v45, v45, v56
    v_mul_f32 v53, v53, v57
    v_mul_f32 v46, v46, v56
    v_mul_f32 v54, v54, v57
    v_mul_f32 v47, v47, v56
    v_mul_f32 v55, v55, v57
    v_cvt_pk_bf16_f32 v60, v40, v41
    v_cvt_pk_bf16_f32 v61, v42, v43
    v_cvt_pk_bf16_f32 v62, v44, v45
    v_cvt_pk_bf16_f32 v63, v46, v47
    v_cvt_pk_bf16_f32 v64, v48, v49
    v_cvt_pk_bf16_f32 v65, v50, v51
    v_cvt_pk_bf16_f32 v66, v52, v53
    v_cvt_pk_bf16_f32 v67, v54, v55
    v_add_u32 v7, 21504, v6
    s_mov_b32 exec_hi, 0x00ffffff
    ds_write_b128 v7, v[60:63]
    s_mov_b32 exec_hi, -1
    s_mov_b32 exec_lo, 0xffffff00
    ds_write_b128 v7, v[64:67] offset:768
    s_mov_b32 exec_lo, -1

    s_mov_b32 s43, 0x9e3779b1
    s_getreg_b32 s13, hwreg(HW_REG_XCC_ID)
    s_and_b32 s13, s13, 15
    s_add_u32 s13, s13, 1
    s_lshl_b32 s12, s13, 1
    v_mul_u32_u24 v9, 896, v24
    s_mul_i32 s13, s8, 224
    s_add_u32 s13, s13, 21504
    v_lshl_add_u32 v9, v2, 3, v9
    v_add_u32 v9, s13, v9
    v_lshrrev_b32 v10, 2, v3
    v_lshl_add_u32 v11, v2, 2, v10
    v_lshrrev_b32 v12, 1, v11
    v_and_b32 v12, 3, v12
    v_lshlrev_b32 v12, 5, v12
    v_and_b32 v13, 3, v3
    v_lshlrev_b32 v13, 3, v13
    v_lshl_add_u32 v10, v11, 6, v13
    v_and_b32 v14, 1, v2
    v_lshl_add_u32 v10, v14, 5, v10
    v_add_u32 v10, 14336, v10
    v_xor_b32 v12, v12, v13
    v_lshl_add_u32 v12, v11, 7, v12
    v_add_u32 v12, 0, v12
    v_xor_b32 v11, 32, v10
    v_xor_b32 v13, 32, v12
    v_xor_b32 v14, 64, v12
    v_xor_b32 v15, 96, v12
    s_waitcnt lgkmcnt(0)

    ds_read2_b64 v[120:123], v9 offset0:0 offset1:4
    ds_read2_b64 v[124:127], v9 offset0:8 offset1:12
    ds_read2_b64 v[128:131], v9 offset0:16 offset1:20
    ds_read_b64 v[132:133], v9 offset:192
    s_mov_b32 s56, 0xffff0000
    s_mov_b32 s57, 0
    s_mov_b32 s58, 0
    s_mov_b32 s59, 0x0000ffff
    s_mov_b32 s60, 0
    s_mov_b32 s61, 0xffff0000
    s_mov_b32 s62, 0xaaaaaaaa
    s_mov_b32 s63, 0xaaaaaaaa

    s_waitcnt vmcnt(21)
    ds_read_b64_tr_b16 v[40:41], v12 offset:0
    ds_read_b64_tr_b16 v[42:43], v12 offset:2048
    ds_read_b64_tr_b16 v[54:55], v13 offset:0
    ds_read_b64_tr_b16 v[56:57], v13 offset:2048
    ds_read_b64_tr_b16 v[68:69], v14 offset:0
    ds_read_b64_tr_b16 v[70:71], v14 offset:2048
    ds_read_b64_tr_b16 v[82:83], v15 offset:0
    ds_read_b64_tr_b16 v[84:85], v15 offset:2048
    s_waitcnt vmcnt(17)
    ds_read_b64_tr_b16 v[44:45], v12 offset:4096
    ds_read_b64_tr_b16 v[46:47], v12 offset:6144
    ds_read_b64_tr_b16 v[58:59], v13 offset:4096
    ds_read_b64_tr_b16 v[60:61], v13 offset:6144
    ds_read_b64_tr_b16 v[72:73], v14 offset:4096
    ds_read_b64_tr_b16 v[74:75], v14 offset:6144
    ds_read_b64_tr_b16 v[86:87], v15 offset:4096
    ds_read_b64_tr_b16 v[88:89], v15 offset:6144
    s_waitcnt lgkmcnt(8)
    v_mfma_f32_16x16x32_bf16 v[96:99], v[120:123], v[40:43], 0
    v_mfma_f32_16x16x32_bf16 v[100:103], v[120:123], v[54:57], 0
    v_mfma_f32_16x16x32_bf16 v[104:107], v[120:123], v[68:71], 0
    v_mfma_f32_16x16x32_bf16 v[108:111], v[120:123], v[82:85], 0
    s_waitcnt vmcnt(13)
    ds_read_b64_tr_b16 v[48:49], v12 offset:8192
    ds_read_b64_tr_b16 v[50:51], v12 offset:10240
    ds_read_b64_tr_b16 v[62:63], v13 offset:8192
    ds_read_b64_tr_b16 v[64:65], v13 offset:10240
    ds_read_b64_tr_b16 v[76:77], v14 offset:8192
    ds_read_b64_tr_b16 v[78:79], v14 offset:10240
    ds_read_b64_tr_b16 v[90:91], v15 offset:8192
    ds_read_b64_tr_b16 v[92:93], v15 offset:10240
    s_waitcnt lgkmcnt(8)
    v_mfma_f32_16x16x32_bf16 v[96:99], v[124:127], v[44:47], v[96:99]
    v_mfma_f32_16x16x32_bf16 v[100:103], v[124:127], v[58:61], v[100:103]
    v_mfma_f32_16x16x32_bf16 v[104:107], v[124:127], v[72:75], v[104:107]
    v_mfma_f32_16x16x32_bf16 v[108:111], v[124:127], v[86:89], v[108:111]
    s_waitcnt vmcnt(10)
    ds_read_b64_tr_b16 v[52:53], v12 offset:12288
    ds_read_b64_tr_b16 v[66:67], v13 offset:12288
    ds_read_b64_tr_b16 v[80:81], v14 offset:12288
    ds_read_b64_tr_b16 v[94:95], v15 offset:12288
    v_mul_lo_u32 v4, v4, s43
    v_add_u32 v4, 0x7f4a7c15, v4
    v_or_b32 v4, 1, v4
    v_xor_b32 v5, s12, v4
    v_mov_b32 v21, v5
    v_mov_b32 v23, v5
    v_mov_b32 v31, v5
    v_mov_b32 v33, v5

    s_waitcnt lgkmcnt(4)
    v_mfma_f32_16x16x32_bf16 v[96:99], v[128:131], v[48:51], v[96:99]
    v_mfma_f32_16x16x32_bf16 v[100:103], v[128:131], v[62:65], v[100:103]
    v_mfma_f32_16x16x32_bf16 v[104:107], v[128:131], v[76:79], v[104:107]
    v_mfma_f32_16x16x32_bf16 v[108:111], v[128:131], v[90:93], v[108:111]
    s_waitcnt lgkmcnt(0)
    v_mfma_f32_16x16x16_bf16 v[96:99], v[132:133], v[52:53], v[96:99]
    v_mfma_f32_16x16x16_bf16 v[100:103], v[132:133], v[66:67], v[100:103]
    v_mfma_f32_16x16x16_bf16 v[104:107], v[132:133], v[80:81], v[104:107]
    v_mfma_f32_16x16x16_bf16 v[108:111], v[132:133], v[94:95], v[108:111]
    s_nop 5
    v_cndmask_b32 v26, v96, v100, s[56:57]
    v_cndmask_b32 v27, v97, v101, s[56:57]
    v_cndmask_b32 v26, v26, v104, s[58:59]
    v_cndmask_b32 v27, v27, v105, s[58:59]
    v_cndmask_b32 v26, v26, v108, s[60:61]
    v_cndmask_b32 v27, v27, v109, s[60:61]
    s_nop 0
    v_mov_b32_dpp v34, v26 quad_perm:[1,0,3,2] row_mask:0xf bank_mask:0xf
    v_mov_b32_dpp v35, v27 quad_perm:[1,0,3,2] row_mask:0xf bank_mask:0xf
    v_cndmask_b32 v20, v26, v35, s[62:63]
    v_cndmask_b32 v22, v34, v27, s[62:63]

    buffer_store_dwordx4 v[20:23], v16, s[52:55], s84 offen
    s_waitcnt vmcnt(4)
    ds_read_b64_tr_b16 v[136:137], v10 offset:0
    ds_read_b64_tr_b16 v[138:139], v10 offset:1024
    ds_read_b64_tr_b16 v[150:151], v11 offset:0
    ds_read_b64_tr_b16 v[152:153], v11 offset:1024
    ds_read_b64_tr_b16 v[140:141], v10 offset:2048
    ds_read_b64_tr_b16 v[142:143], v10 offset:3072
    ds_read_b64_tr_b16 v[154:155], v11 offset:2048
    ds_read_b64_tr_b16 v[156:157], v11 offset:3072
    ds_read_b64_tr_b16 v[144:145], v10 offset:4096
    ds_read_b64_tr_b16 v[146:147], v10 offset:5120
    ds_read_b64_tr_b16 v[158:159], v11 offset:4096
    ds_read_b64_tr_b16 v[160:161], v11 offset:5120
    ds_read_b64_tr_b16 v[148:149], v10 offset:6144
    ds_read_b64_tr_b16 v[162:163], v11 offset:6144
    v_mov_b32 v108, v20
    v_mov_b32 v109, v4
    v_mov_b32 v110, v22
    v_mov_b32 v111, v4
    s_add_u32 s48, s84, 393216
    s_add_u32 s49, s85, 393216

    s_waitcnt lgkmcnt(10)
    v_mfma_f32_16x16x32_bf16 v[96:99], v[120:123], v[136:139], 0
    v_mfma_f32_16x16x32_bf16 v[100:103], v[120:123], v[150:153], 0
    s_waitcnt lgkmcnt(6)
    v_mfma_f32_16x16x32_bf16 v[96:99], v[124:127], v[140:143], v[96:99]
    v_mfma_f32_16x16x32_bf16 v[100:103], v[124:127], v[154:157], v[100:103]
    s_waitcnt lgkmcnt(2)
    v_mfma_f32_16x16x32_bf16 v[96:99], v[128:131], v[144:147], v[96:99]
    v_mfma_f32_16x16x32_bf16 v[100:103], v[128:131], v[158:161], v[100:103]
    s_waitcnt lgkmcnt(0)
    v_mfma_f32_16x16x16_bf16 v[96:99], v[132:133], v[148:149], v[96:99]
    v_mfma_f32_16x16x16_bf16 v[100:103], v[132:133], v[162:163], v[100:103]
    s_nop 7
    v_cndmask_b32 v26, v96, v100, s[56:57]
    v_cndmask_b32 v27, v97, v101, s[56:57]

    s_nop 0
    v_mov_b32_dpp v34, v26 quad_perm:[1,0,3,2] row_mask:0xf bank_mask:0xf
    v_mov_b32_dpp v35, v27 quad_perm:[1,0,3,2] row_mask:0xf bank_mask:0xf
    v_cndmask_b32 v30, v26, v35, s[62:63]
    v_cndmask_b32 v32, v34, v27, s[62:63]

    s_cmp_lt_u32 s9, s90
    s_cbranch_scc0 L_nohpub
    s_mov_b32 exec_hi, 0
    buffer_store_dwordx4 v[30:33], v17, s[52:55], s85 offen

    s_mov_b32 exec_hi, -1
L_nohpub:
    v_mov_b32 v104, v30
    v_mov_b32 v105, v4
    v_mov_b32 v106, v32
    v_mov_b32 v107, v4
    s_lshl_b32 s10, s4, 1
    s_add_u32 s10, s10, s6
    s_lshl_b32 s10, s10, 14
    s_add_u32 s10, s10, 4096
    s_add_u32 s11, s10, 4096
    s_add_u32 s44, s10, 8192
    s_add_u32 s45, s10, 12288
    s_lshl_b32 s14, s14, 11
    s_add_u32 s14, s14, 266240
    s_mov_b32 s46, 393216
    s_mov_b32 s47, 6
    v_mul_u32_u24 v134, 4682, v1
    v_lshrrev_b32 v134, 16, v134
    v_mul_u32_u24 v134, 672, v134
    v_add_u32 v134, v134, v6
    s_mov_b32 s96, s32
    s_mov_b32 s97, s33
    s_cmp_lt_u32 s9, s90
    s_cselect_b32 s98, 1605632, 0
    s_mov_b32 s99, 0x20000
    s_mul_i32 s86, s15, 28672
    s_mul_i32 s13, s8, 224
    s_add_u32 s86, s86, s13

    s_mul_i32 s87, s8, 57344
    s_lshl_b32 s13, s15, 6
    s_add_u32 s87, s87, s13
    s_add_u32 s87, s87, 2916352
    s_add_u32 s88, s87, 229376
    v_lshrrev_b32 v164, 2, v3
    v_lshl_add_u32 v164, v2, 2, v164
    v_and_b32 v34, 3, v3
    v_mul_u32_u24 v135, 224, v164
    v_lshl_add_u32 v135, v34, 3, v135
    v_add_u32 v135, 0, v135
    v_mul_u32_u24 v165, 3584, v164
    v_lshl_add_u32 v165, v34, 4, v165
    v_lshlrev_b32 v164, 6, v24
    v_lshl_add_u32 v164, v2, 3, v164
    v_add_u32 v164, 24928, v164
    s_mov_b32 s89, 1
    s_mov_b32 m0, 0

    v_lshlrev_b32 v165, 3, v1
    v_add_u32 v165, 21504, v165
    v_mov_b32 v144, 0
    v_mov_b32 v145, 0
    v_mov_b32 v146, 0
    v_mov_b32 v147, 0
    v_mov_b32 v148, 0
    v_mov_b32 v149, 0
    v_mov_b32 v150, 0
    v_mov_b32 v151, 0
    v_mov_b32 v152, 0
    v_mov_b32 v153, 0
    v_mov_b32 v154, 0
    v_mov_b32 v155, 0
    v_mov_b32 v156, 0
    v_mov_b32 v157, 0
    v_mov_b32 v158, 0
    v_mov_b32 v159, 0
    s_waitcnt vmcnt(0)
L_qpass:
    buffer_load_dwordx4 v[32:35], v6, s[52:55], s10 offen offset:0 sc1
    buffer_load_dwordx4 v[36:39], v6, s[52:55], s10 offen offset:1024 sc1
    buffer_load_dwordx4 v[40:43], v6, s[52:55], s10 offen offset:2048 sc1
    buffer_load_dwordx4 v[44:47], v6, s[52:55], s10 offen offset:3072 sc1
    buffer_load_dwordx4 v[48:51], v6, s[52:55], s11 offen offset:0 sc1
    buffer_load_dwordx4 v[52:55], v6, s[52:55], s11 offen offset:1024 sc1
    buffer_load_dwordx4 v[56:59], v6, s[52:55], s11 offen offset:2048 sc1
    buffer_load_dwordx4 v[60:63], v6, s[52:55], s11 offen offset:3072 sc1
    buffer_load_dwordx4 v[64:67], v6, s[52:55], s44 offen offset:0 sc1
    buffer_load_dwordx4 v[68:71], v6, s[52:55], s44 offen offset:1024 sc1
    buffer_load_dwordx4 v[72:75], v6, s[52:55], s44 offen offset:2048 sc1
    buffer_load_dwordx4 v[76:79], v6, s[52:55], s44 offen offset:3072 sc1
    buffer_load_dwordx4 v[80:83], v6, s[52:55], s45 offen offset:0 sc1
    buffer_load_dwordx4 v[84:87], v6, s[52:55], s45 offen offset:1024 sc1
    buffer_load_dwordx4 v[88:91], v6, s[52:55], s45 offen offset:2048 sc1
    buffer_load_dwordx4 v[92:95], v6, s[52:55], s45 offen offset:3072 sc1
    buffer_load_dwordx4 v[96:99], v6, s[52:55], s14 offen sc1
    buffer_load_dwordx4 v[100:103], v6, s[52:55], s14 offen offset:1024 sc1

L_qw0:
    s_waitcnt vmcnt(0)
L_qchk:

    v_cmpx_eq_u32 vcc, v5, v33
    v_cmpx_eq_u32 vcc, v5, v35
    v_cmpx_eq_u32 vcc, v5, v37
    v_cmpx_eq_u32 vcc, v5, v39
    v_cmpx_eq_u32 vcc, v5, v41
    v_cmpx_eq_u32 vcc, v5, v43
    v_cmpx_eq_u32 vcc, v5, v45
    v_cmpx_eq_u32 vcc, v5, v47
    v_cmpx_eq_u32 vcc, v5, v49
    v_cmpx_eq_u32 vcc, v5, v51
    v_cmpx_eq_u32 vcc, v5, v53
    v_cmpx_eq_u32 vcc, v5, v55
    v_cmpx_eq_u32 vcc, v5, v57
    v_cmpx_eq_u32 vcc, v5, v59
    v_cmpx_eq_u32 vcc, v5, v61
    v_cmpx_eq_u32 vcc, v5, v63
    v_cmpx_eq_u32 vcc, v5, v65
    v_cmpx_eq_u32 vcc, v5, v67
    v_cmpx_eq_u32 vcc, v5, v69
    v_cmpx_eq_u32 vcc, v5, v71
    v_cmpx_eq_u32 vcc, v5, v73
    v_cmpx_eq_u32 vcc, v5, v75
    v_cmpx_eq_u32 vcc, v5, v77
    v_cmpx_eq_u32 vcc, v5, v79
    v_cmpx_eq_u32 vcc, v5, v81
    v_cmpx_eq_u32 vcc, v5, v83
    v_cmpx_eq_u32 vcc, v5, v85
    v_cmpx_eq_u32 vcc, v5, v87
    v_cmpx_eq_u32 vcc, v5, v89
    v_cmpx_eq_u32 vcc, v5, v91
    v_cmpx_eq_u32 vcc, v5, v93
    v_cmpx_eq_u32 vcc, v5, v95
    v_cmpx_eq_u32 vcc, v5, v97
    v_cmpx_eq_u32 vcc, v5, v99
    v_cmpx_eq_u32 vcc, v5, v101
    v_cmpx_eq_u32 vcc, v5, v103
    s_nop 1
    s_cmp_eq_u64 exec, -1
    s_mov_b64 exec, -1
    s_cbranch_scc1 L_qok

    s_sub_u32 s47, s47, 1
    s_cmp_gt_i32 s47, 0
    s_cbranch_scc1 L_qnext

    s_cmp_eq_u32 s47, 0
    s_cbranch_scc0 L_nohpub2
    buffer_store_dwordx4 v[108:111], v16, s[52:55], s48 offen sc1
    s_cmp_lt_u32 s9, s90
    s_cbranch_scc0 L_nohpub2
    s_mov_b32 exec_hi, 0
    buffer_store_dwordx4 v[104:107], v17, s[52:55], s49 offen sc1
    s_mov_b32 exec_hi, -1
L_nohpub2:

    s_add_u32 s10, s10, s46
    s_add_u32 s11, s11, s46
    s_add_u32 s44, s44, s46
    s_add_u32 s45, s45, s46
    s_add_u32 s14, s14, s46
    s_sub_u32 s46, 0, s46
    v_xor_b32 v5, s12, v5

L_qnext:
    s_sub_u32 s42, s42, 1
    s_cmp_gt_i32 s42, 0
    s_cbranch_scc1 L_qpass
L_qok:

    v_add_f32 v32, v32, v48
    v_add_f32 v34, v34, v50
    v_add_f32 v36, v36, v52
    v_add_f32 v38, v38, v54
    v_add_f32 v40, v40, v56
    v_add_f32 v42, v42, v58
    v_add_f32 v44, v44, v60
    v_add_f32 v46, v46, v62
    v_add_f32 v32, v32, v64
    v_add_f32 v34, v34, v66
    v_add_f32 v36, v36, v68
    v_add_f32 v38, v38, v70
    v_add_f32 v40, v40, v72
    v_add_f32 v42, v42, v74
    v_add_f32 v44, v44, v76
    v_add_f32 v46, v46, v78
    v_add_f32 v32, v32, v80
    v_add_f32 v34, v34, v82
    v_add_f32 v36, v36, v84
    v_add_f32 v38, v38, v86
    v_add_f32 v40, v40, v88
    v_add_f32 v42, v42, v90
    v_add_f32 v44, v44, v92
    v_add_f32 v46, v46, v94
    v_cvt_pk_bf16_f32 v20, v32, v34
    v_cvt_pk_bf16_f32 v21, v36, v38
    v_cvt_pk_bf16_f32 v22, v40, v42
    v_cvt_pk_bf16_f32 v23, v44, v46
    v_lshlrev_b32 v16, 2, v1
    v_add_u32 v17, 23296, v16
    ds_write_b32 v17, v20 offset:0
    ds_write_b32 v17, v21 offset:256
    ds_write_b32 v17, v22 offset:512
    ds_write_b32 v17, v23 offset:768
    s_cmp_eq_u32 s46, 393216
    s_cselect_b32 s13, 1, 0
    v_mov_b32 v24, s13
    v_cndmask_b32 v24, v4, v24, s[62:63]
    v_add_u32 v17, 24896, v16
    s_mov_b64 exec, 0xff
    ds_write_b32 v17, v24
    s_mov_b64 exec, -1

    s_waitcnt lgkmcnt(0)
    s_barrier
    v_add_f32 v96, v96, v100
    v_add_f32 v98, v98, v102
    v_lshlrev_b32 v26, 16, v28
    v_and_b32 v27, 0xffff0000, v28

    v_mov_b32 v97, v96
    v_mov_b32 v99, v98
    s_nop 0
    v_permlane32_swap_b32 v96, v97
    v_permlane32_swap_b32 v98, v99
    v_add_f32 v96, v96, v97
    v_add_f32 v98, v98, v99
    v_cvt_pk_bf16_f32 v100, v96, v98
    v_lshlrev_b32 v96, 16, v100
    v_and_b32 v98, 0xffff0000, v100
    v_add_f32 v96, v96, v26
    v_add_f32 v98, v98, v27
    v_cvt_pk_bf16_f32 v100, v96, v98
    v_lshlrev_b32 v96, 16, v100
    v_and_b32 v98, 0xffff0000, v100
    v_max_f32 v96, 0, v96
    v_max_f32 v98, 0, v98
    v_mul_f32 v96, v96, v96
    v_mul_f32 v98, v98, v98
    v_cvt_pk_bf16_f32 v96, v96, v98
    v_add_u32 v17, 24928, v16
    s_mov_b32 exec_hi, 0
    ds_write_b32 v17, v96
    s_mov_b32 exec_hi, -1
    s_barrier

    s_mov_b32 exec_lo, 0xf000f
    s_mov_b32 exec_hi, 0xf000f
    ds_read2_b64 v[144:147], v164 offset0:0 offset1:4
    s_mov_b32 exec_lo, 0xf000f0
    s_mov_b32 exec_hi, 0xf000f0
    ds_read2_b64 v[148:151], v164 offset0:0 offset1:4
    s_mov_b32 exec_lo, 0xf000f00
    s_mov_b32 exec_hi, 0xf000f00
    ds_read2_b64 v[152:155], v164 offset0:0 offset1:4
    s_mov_b32 exec_lo, 0xf000f000
    s_mov_b32 exec_hi, 0xf000f000
    ds_read2_b64 v[156:159], v164 offset0:0 offset1:4
    s_mov_b64 exec, -1
    s_barrier
    s_mov_b32 exec_hi, 0x00ffffff
    buffer_load_dwordx4 v134, s[96:99], s86 offen nt lds
    s_add_u32 m0, m0, 896
    s_add_u32 s86, s86, 3584
    buffer_load_dwordx4 v134, s[96:99], s86 offen nt lds
    s_add_u32 m0, m0, 896
    s_add_u32 s86, s86, 3584
    buffer_load_dwordx4 v134, s[96:99], s86 offen nt lds
    s_add_u32 m0, m0, 896
    s_add_u32 s86, s86, 3584
    buffer_load_dwordx4 v134, s[96:99], s86 offen nt lds
    s_add_u32 m0, m0, 896
    s_add_u32 s86, s86, 3584
    buffer_load_dwordx4 v134, s[96:99], s86 offen nt lds
    s_add_u32 m0, m0, 896
    s_add_u32 s86, s86, 3584
    buffer_load_dwordx4 v134, s[96:99], s86 offen nt lds
    s_add_u32 m0, m0, 896
    s_add_u32 s86, s86, 3584
    buffer_load_dwordx4 v134, s[96:99], s86 offen nt lds
    s_add_u32 m0, m0, 896
    s_add_u32 s86, s86, 3584
    buffer_load_dwordx4 v134, s[96:99], s86 offen nt lds
    s_mov_b32 exec_hi, -1
    s_barrier
    s_waitcnt vmcnt(0)
    ds_read_b64_tr_b16 v[40:41], v135 offset:0
    ds_read_b64_tr_b16 v[42:43], v135 offset:3584
    ds_read_b64_tr_b16 v[56:57], v135 offset:128
    ds_read_b64_tr_b16 v[58:59], v135 offset:3712
    ds_read_b64_tr_b16 v[44:45], v135 offset:32
    ds_read_b64_tr_b16 v[46:47], v135 offset:3616
    ds_read_b64_tr_b16 v[60:61], v135 offset:160
    ds_read_b64_tr_b16 v[62:63], v135 offset:3744
    ds_read_b64_tr_b16 v[48:49], v135 offset:64
    ds_read_b64_tr_b16 v[50:51], v135 offset:3648
    ds_read_b64_tr_b16 v[64:65], v135 offset:192
    ds_read_b64_tr_b16 v[66:67], v135 offset:3776
    ds_read_b64_tr_b16 v[52:53], v135 offset:96
    ds_read_b64_tr_b16 v[54:55], v135 offset:3680
    s_mov_b64 exec, -1
    v_mov_b32 v113, v4
    v_mov_b32 v115, v4
    v_mov_b32 v117, v4
    v_mov_b32 v119, v4
    s_cmp_lt_u32 s9, s90

    s_waitcnt lgkmcnt(12)
    v_mfma_f32_16x16x32_bf16 v[104:107], v[144:147], v[40:43], 0
    s_waitcnt lgkmcnt(10)
    v_mfma_f32_16x16x32_bf16 v[108:111], v[144:147], v[56:59], 0
    s_waitcnt lgkmcnt(8)
    v_mfma_f32_16x16x32_bf16 v[104:107], v[148:151], v[44:47], v[104:107]
    s_waitcnt lgkmcnt(6)
    v_mfma_f32_16x16x32_bf16 v[108:111], v[148:151], v[60:63], v[108:111]
    s_waitcnt lgkmcnt(4)
    v_mfma_f32_16x16x32_bf16 v[104:107], v[152:155], v[48:51], v[104:107]
    s_waitcnt lgkmcnt(2)
    v_mfma_f32_16x16x32_bf16 v[108:111], v[152:155], v[64:67], v[108:111]
    s_waitcnt lgkmcnt(0)
    v_mfma_f32_16x16x32_bf16 v[104:107], v[156:159], v[52:55], v[104:107]
    s_nop 7
    ds_write2_b32 v165, v104, v108 offset0:0 offset1:1
    ds_write2_b32 v165, v105, v109 offset0:128 offset1:129
    s_waitcnt lgkmcnt(0)

    s_endpgm
L_codeend:
    .if (L_awave - recurrent_scan__sliding_block_cached__dense_activation_squared_relu__decode_kernel) > 256
    .error "head too long"
    .endif
    .if (L_av - L_awave) > 1024
    .error "second window too long"
    .endif
.section .rodata,"a"
.p2align 6
.amdhsa_kernel recurrent_scan__sliding_block_cached__dense_activation_squared_relu__decode_kernel
  .amdhsa_next_free_vgpr 224
  .amdhsa_next_free_sgpr 102
  .amdhsa_accum_offset 224
  .amdhsa_group_segment_fixed_size 0
  .amdhsa_kernarg_size 104
  .amdhsa_user_sgpr_count 2
  .amdhsa_user_sgpr_kernarg_segment_ptr 1
  .amdhsa_system_sgpr_workgroup_id_x 1
.end_amdhsa_kernel
```
